```python
import torch

def _softmax(x, axis=-1):
    return torch.softmax(x, dim=axis)
def _gelu(x):
    return torch.nn.functional.gelu(x, approximate="tanh")
def _silu(x):
    return torch.nn.functional.silu(x)
def _sigmoid(x):
    return torch.sigmoid(x)
def _layernorm(x, axis=-1, eps=1e-5):
    m = x.mean(dim=axis, keepdim=True)
    v = x.var(dim=axis, keepdim=True, unbiased=False)
    return (x - m) / torch.sqrt(v + eps)
def _scatter_add(tgt, idx, src, axis=0):
    return tgt.clone().index_add_(axis, idx, src)
def _segment_sum(src, seg, n):
    out = torch.zeros((n,) + src.shape[1:], dtype=src.dtype)
    return out.index_add_(0, seg, src)
def _pad(x, pw):
    flat = tuple(v for pair in reversed(pw) for v in pair)
    return torch.nn.functional.pad(x, flat)

kernel_name = 'concat_heads__grouped_kv_mqa__grouped_kv_mqa__prompt'

def setup_inputs():

    _w = (lambda a: (lambda t: t.to(torch.bfloat16) if t.is_floating_point() else t)(torch.as_tensor(a)))
    def _A_setup():
        B, S, D, H = 1, 2048, 1024, 32
        Dh = D // H
        return {
            "x": _w((lambda *s: torch.randn(*s, dtype=torch.bfloat16) * 0.05)(B, S, D)),
            "wq": _w((lambda *s: torch.randn(*s, dtype=torch.bfloat16) * 0.8)(D, H * Dh)),
            "wk": _w((lambda *s: torch.randn(*s, dtype=torch.bfloat16) * 0.8)(D, Dh)),
            "wv": _w((lambda *s: torch.randn(*s, dtype=torch.bfloat16) * 0.05)(D, Dh)),
            "wo": _w((lambda *s: torch.randn(*s, dtype=torch.bfloat16) * 0.05)(H * Dh, D)),
        }
    _A_in = _A_setup()

    def _B_setup():
        B, S, D, H = 1, 2048, 1024, 32
        Dh = D // H
        return {
            "x": _w((lambda *s: torch.randn(*s, dtype=torch.bfloat16) * 0.05)(B, S, D)),
            "wq": _w((lambda *s: torch.randn(*s, dtype=torch.bfloat16) * 0.8)(D, H * Dh)),
            "wk": _w((lambda *s: torch.randn(*s, dtype=torch.bfloat16) * 0.8)(D, Dh)),
            "wv": _w((lambda *s: torch.randn(*s, dtype=torch.bfloat16) * 0.05)(D, Dh)),
            "wo": _w((lambda *s: torch.randn(*s, dtype=torch.bfloat16) * 0.05)(H * Dh, D)),
        }
    _B_in = _B_setup()

    return {
        "A_x": _A_in["x"],
        "A_wq": _A_in["wq"],
        "A_wk": _A_in["wk"],
        "A_wv": _A_in["wv"],
        "A_wo": _A_in["wo"],
        "B_x": _B_in["x"],
        "B_wq": _B_in["wq"],
        "B_wk": _B_in["wk"],
        "B_wv": _B_in["wv"],
        "B_wo": _B_in["wo"],
    }

def reference(A_x, A_wq, A_wk, A_wv, A_wo, B_x, B_wq, B_wk, B_wv, B_wo):
    def _A_ref(x, wq, wk, wv, wo):
        B, S, D = x.shape
        H = 32
        Dh = D // H
        q = (lambda x, *d: x.permute(*d))((x @ wq).reshape(B, S, H, Dh), 0, 2, 1, 3)
        k = x @ wk
        v = x @ wv
        scores = torch.einsum("bhqd,bkd->bhqk", q, k) * (Dh ** -0.5)
        p = _softmax(scores, axis=-1)
        o = torch.einsum("bhqk,bkd->bhqd", p, v)
        return (lambda x, *d: x.permute(*d))(o, 0, 2, 1, 3).reshape(B, S, H * Dh) @ wo

    def _B_ref(x, wq, wk, wv, wo):
        B, S, D = x.shape
        H = 32
        Dh = D // H
        q = (lambda x, *d: x.permute(*d))((x @ wq).reshape(B, S, H, Dh), 0, 2, 1, 3)
        k = x @ wk
        v = x @ wv
        scores = torch.einsum("bhqd,bkd->bhqk", q, k) * (Dh ** -0.5)
        p = _softmax(scores, axis=-1)
        o = torch.einsum("bhqk,bkd->bhqd", p, v)
        return (lambda x, *d: x.permute(*d))(o, 0, 2, 1, 3).reshape(B, S, H * Dh) @ wo

    a = _A_ref(A_x, A_wq, A_wk, A_wv, A_wo)
    b = _B_ref(B_x, B_wq, B_wk, B_wv, B_wo)
    return torch.concatenate([a, b], axis=-1)
```

```asm
; @launch grid=(256,1,1) block=(768,1,1) lds=163840
.amdgcn_target "amdgcn-amd-amdhsa--gfx950"
.text
.globl concat_heads__grouped_kv_mqa__grouped_kv_mqa__prompt_kernel
.p2align 8
.type concat_heads__grouped_kv_mqa__grouped_kv_mqa__prompt_kernel,@function
concat_heads__grouped_kv_mqa__grouped_kv_mqa__prompt_kernel:
    s_cmp_ge_u32 s2, 256
    s_cbranch_scc1 L_end
    s_and_b32 s4, s2, 7
    s_lshr_b32 s5, s2, 3
    s_lshr_b32 s3, s4, 2
    s_and_b32 s4, s4, 3
    s_lshl_b32 s4, s4, 2
    s_lshr_b32 s6, s5, 3
    s_add_u32 s4, s4, s6
    s_and_b32 s5, s5, 7
    s_load_dwordx16 s[16:31], s[0:1], 0
    s_load_dwordx4 s[32:35], s[0:1], 64
    s_load_dwordx2 s[50:51], s[0:1], 80
    s_load_dwordx2 s[36:37], s[0:1], 88
    s_load_dwordx2 s[52:53], s[0:1], 96
    s_waitcnt lgkmcnt(0)
    s_cmp_eq_u32 s3, 0
    s_cselect_b32 s40, s16, s26
    s_cselect_b32 s41, s17, s27
    s_cselect_b32 s42, s18, s28
    s_cselect_b32 s43, s19, s29
    s_cselect_b32 s44, s20, s30
    s_cselect_b32 s45, s21, s31
    s_cselect_b32 s46, s22, s32
    s_cselect_b32 s47, s23, s33
    s_cselect_b32 s48, s24, s34
    s_cselect_b32 s49, s25, s35
    v_lshrrev_b32 v1, 6, v0
    v_and_b32 v2, 63, v0
    v_readfirstlane_b32 s6, v1
    s_mov_b32 s56, s52
    s_and_b32 s57, s53, 0xffff
    s_mov_b32 s58, 0x10000000
    s_mov_b32 s59, 0x00020000
    s_mov_b32 s8, s40
    s_and_b32 s9, s41, 0xffff
    s_mov_b32 s10, 0x400000
    s_mov_b32 s11, 0x00020000
    s_mov_b32 s12, s42
    s_and_b32 s13, s43, 0xffff
    s_mov_b32 s14, 0x200000
    s_mov_b32 s15, 0x00020000
    s_and_b32 s60, s5, 1
    s_cmp_eq_u32 s60, 0
    s_cselect_b32 s54, s44, s46
    s_cselect_b32 s55, s45, s47
    s_mov_b32 s88, s54
    s_and_b32 s89, s55, 0xffff
    s_mov_b32 s90, 0x10000
    s_mov_b32 s91, 0x00020000
    s_mov_b32 s84, s50
    s_and_b32 s85, s51, 0xffff
    s_mov_b32 s86, 0x800000
    s_mov_b32 s87, 0x00020000
    s_lshl_b32 s7, s4, 7
    s_cmp_lt_u32 s6, 8
    s_cbranch_scc1 L_compute
    s_sub_u32 s62, s6, 8
    s_lshl_b32 s60, s3, 4
    s_add_u32 s60, s60, s4
    s_lshl_b32 s60, s60, 10
    s_add_u32 s60, s60, 10485760
    v_and_b32 v20, 7, v2
    v_lshlrev_b32 v20, 7, v20
    v_add_u32 v20, s60, v20
    s_lshr_b32 s60, s5, 1
    s_lshl_b32 s60, s60, 5
    s_add_u32 s60, s60, s7
    s_lshl_b32 s65, s62, 3
    s_add_u32 s60, s60, s65
    s_lshl_b32 s72, s60, 11
    v_lshrrev_b32 v24, 4, v2
    v_and_b32 v25, 15, v2
    s_and_b32 s65, s65, 15
    v_add_u32 v26, 0, v24
    v_add_u32 v27, s65, v26
    v_xor_b32 v27, v27, v25
    v_lshlrev_b32 v27, 4, v27
    v_lshl_add_u32 v32, v26, 11, v27
    v_add_u32 v26, 4, v24
    v_add_u32 v27, s65, v26
    v_xor_b32 v27, v27, v25
    v_lshlrev_b32 v27, 4, v27
    v_lshl_add_u32 v33, v26, 11, v27
    v_subrev_u32 v33, 1024, v33
    v_lshlrev_b32 v34, 4, v2
    s_lshl_b32 s74, s62, 11
    s_and_b32 s77, s5, 1
    s_lshl_b32 s77, s77, 2
    s_lshr_b32 s78, s2, 3
    s_and_b32 s77, s77, 7
    s_lshl_b32 s60, s77, 13
    s_add_u32 s60, s60, s74
    s_add_u32 m0, s60, 32768
    s_lshl_b32 s65, s77, 8
    s_add_u32 s65, s65, s72
    buffer_load_dwordx4 v32, s[8:11], s65 offen offset:0  lds
    buffer_load_dwordx4 v33, s[8:11], s65 offen offset:1024  lds
    s_add_u32 s77, s77, 1
    s_and_b32 s78, s78, 7
    s_lshl_b32 s60, s78, 13
    s_add_u32 s60, s60, s74
    s_add_u32 m0, s60, 98304
    s_add_u32 s78, s78, 1
    buffer_load_dwordx4 v34, s[88:91], s60 offen offset:0  lds
    buffer_load_dwordx4 v34, s[88:91], s60 offen offset:1024  lds
    s_and_b32 s77, s77, 7
    s_lshl_b32 s60, s77, 13
    s_add_u32 s60, s60, s74
    s_add_u32 m0, s60, 32768
    s_lshl_b32 s65, s77, 8
    s_add_u32 s65, s65, s72
    buffer_load_dwordx4 v32, s[8:11], s65 offen offset:0  lds
    buffer_load_dwordx4 v33, s[8:11], s65 offen offset:1024  lds
    s_add_u32 s77, s77, 1
    s_and_b32 s78, s78, 7
    s_lshl_b32 s60, s78, 13
    s_add_u32 s60, s60, s74
    s_add_u32 m0, s60, 98304
    s_add_u32 s78, s78, 1
    buffer_load_dwordx4 v34, s[88:91], s60 offen offset:0  lds
    buffer_load_dwordx4 v34, s[88:91], s60 offen offset:1024  lds
    s_and_b32 s77, s77, 7
    s_lshl_b32 s60, s77, 13
    s_add_u32 s60, s60, s74
    s_add_u32 m0, s60, 32768
    s_lshl_b32 s65, s77, 8
    s_add_u32 s65, s65, s72
    buffer_load_dwordx4 v32, s[8:11], s65 offen offset:0  lds
    buffer_load_dwordx4 v33, s[8:11], s65 offen offset:1024  lds
    s_add_u32 s77, s77, 1
    s_and_b32 s78, s78, 7
    s_lshl_b32 s60, s78, 13
    s_add_u32 s60, s60, s74
    s_add_u32 m0, s60, 98304
    s_add_u32 s78, s78, 1
    buffer_load_dwordx4 v34, s[88:91], s60 offen offset:0  lds
    buffer_load_dwordx4 v34, s[88:91], s60 offen offset:1024  lds
    s_and_b32 s77, s77, 7
    s_lshl_b32 s60, s77, 13
    s_add_u32 s60, s60, s74
    s_add_u32 m0, s60, 32768
    s_lshl_b32 s65, s77, 8
    s_add_u32 s65, s65, s72
    buffer_load_dwordx4 v32, s[8:11], s65 offen offset:0  lds
    buffer_load_dwordx4 v33, s[8:11], s65 offen offset:1024  lds
    s_add_u32 s77, s77, 1
    s_and_b32 s78, s78, 7
    s_lshl_b32 s60, s78, 13
    s_add_u32 s60, s60, s74
    s_add_u32 m0, s60, 98304
    s_add_u32 s78, s78, 1
    buffer_load_dwordx4 v34, s[88:91], s60 offen offset:0  lds
    buffer_load_dwordx4 v34, s[88:91], s60 offen offset:1024  lds
    s_and_b32 s77, s77, 7
    s_lshl_b32 s60, s77, 13
    s_add_u32 s60, s60, s74
    s_add_u32 m0, s60, 32768
    s_lshl_b32 s65, s77, 8
    s_add_u32 s65, s65, s72
    buffer_load_dwordx4 v32, s[8:11], s65 offen offset:0  lds
    buffer_load_dwordx4 v33, s[8:11], s65 offen offset:1024  lds
    s_add_u32 s77, s77, 1
    s_and_b32 s78, s78, 7
    s_lshl_b32 s60, s78, 13
    s_add_u32 s60, s60, s74
    s_add_u32 m0, s60, 98304
    s_add_u32 s78, s78, 1
    buffer_load_dwordx4 v34, s[88:91], s60 offen offset:0  lds
    buffer_load_dwordx4 v34, s[88:91], s60 offen offset:1024  lds
    s_and_b32 s77, s77, 7
    s_lshl_b32 s60, s77, 13
    s_add_u32 s60, s60, s74
    s_add_u32 m0, s60, 32768
    s_lshl_b32 s65, s77, 8
    s_add_u32 s65, s65, s72
    buffer_load_dwordx4 v32, s[8:11], s65 offen offset:0  lds
    buffer_load_dwordx4 v33, s[8:11], s65 offen offset:1024  lds
    s_add_u32 s77, s77, 1
    s_and_b32 s78, s78, 7
    s_lshl_b32 s60, s78, 13
    s_add_u32 s60, s60, s74
    s_add_u32 m0, s60, 98304
    s_add_u32 s78, s78, 1
    buffer_load_dwordx4 v34, s[88:91], s60 offen offset:0  lds
    buffer_load_dwordx4 v34, s[88:91], s60 offen offset:1024  lds
    s_and_b32 s77, s77, 7
    s_lshl_b32 s60, s77, 13
    s_add_u32 s60, s60, s74
    s_add_u32 m0, s60, 32768
    s_lshl_b32 s65, s77, 8
    s_add_u32 s65, s65, s72
    buffer_load_dwordx4 v32, s[8:11], s65 offen offset:0  lds
    buffer_load_dwordx4 v33, s[8:11], s65 offen offset:1024  lds
    s_add_u32 s77, s77, 1
    s_and_b32 s78, s78, 7
    s_lshl_b32 s60, s78, 13
    s_add_u32 s60, s60, s74
    s_add_u32 m0, s60, 98304
    s_add_u32 s78, s78, 1
    buffer_load_dwordx4 v34, s[88:91], s60 offen offset:0  lds
    buffer_load_dwordx4 v34, s[88:91], s60 offen offset:1024  lds
    s_and_b32 s77, s77, 7
    s_lshl_b32 s60, s77, 13
    s_add_u32 s60, s60, s74
    s_add_u32 m0, s60, 32768
    s_lshl_b32 s65, s77, 8
    s_add_u32 s65, s65, s72
    buffer_load_dwordx4 v32, s[8:11], s65 offen offset:0  lds
    buffer_load_dwordx4 v33, s[8:11], s65 offen offset:1024  lds
    s_add_u32 s77, s77, 1
    s_and_b32 s78, s78, 7
    s_lshl_b32 s60, s78, 13
    s_add_u32 s60, s60, s74
    s_add_u32 m0, s60, 98304
    s_add_u32 s78, s78, 1
    buffer_load_dwordx4 v34, s[88:91], s60 offen offset:0  lds
    buffer_load_dwordx4 v34, s[88:91], s60 offen offset:1024  lds
    v_lshrrev_b32 v24, 4, v2
    v_bfe_u32 v25, v2, 1, 3
    v_lshlrev_b32 v26, 1, v24
    v_xor_b32 v25, v25, v26
    v_lshlrev_b32 v24, 11, v24
    v_and_b32 v26, 1, v2
    v_lshl_add_u32 v24, v26, 4, v24
    s_lshl_b32 s60, s62, 15
    s_lshl_b32 s65, s5, 8
    s_add_u32 s60, s60, s65
    v_add_u32 v24, s60, v24
    v_xor_b32 v26, 0, v25
    v_lshl_add_u32 v8, v26, 5, v24
    v_xor_b32 v26, 1, v25
    v_lshl_add_u32 v9, v26, 5, v24
    v_add_u32 v9, 7168, v9
    v_xor_b32 v26, 1, v25
    v_lshl_add_u32 v10, v26, 5, v24
    v_add_u32 v10, 14336, v10
    v_xor_b32 v26, 0, v25
    v_lshl_add_u32 v11, v26, 5, v24
    v_add_u32 v11, 21504, v11
    v_lshrrev_b32 v24, 3, v2
    s_lshl_b32 s60, s62, 5
    s_add_u32 s60, s60, s7
    v_add_u32 v24, s60, v24
    v_lshlrev_b32 v24, 11, v24
    v_and_b32 v25, 7, v2
    v_lshrrev_b32 v26, 4, v2
    v_xor_b32 v25, v25, v26
    v_lshl_add_u32 v12, v25, 4, v24
    v_xor_b32 v27, 4, v25
    v_lshl_add_u32 v13, v27, 4, v24
    v_add_u32 v13, 15360, v13
    v_lshl_add_u32 v14, v25, 4, v24
    v_add_u32 v14, 30720, v14
    v_xor_b32 v27, 4, v25
    v_lshl_add_u32 v15, v27, 4, v24
    v_add_u32 v15, 46080, v15
    s_lshl_b32 s63, s62, 12
    s_lshl_b32 s64, s62, 12
    s_add_u32 s64, s64, 16384
    s_and_b32 s60, s4, 3
    s_lshl_b32 s60, s60, 2
    s_lshl_b32 s65, s5, 1
    s_add_u32 s60, s60, s65
    s_and_b32 s60, s60, 15
    s_lshl_b32 s66, s60, 17
    s_lshl_b32 s67, s60, 7
    s_add_u32 m0, s63, 0
    s_nop 0
    buffer_load_dwordx4 v8, s[12:15], s66 offen offset:0  lds
    buffer_load_dwordx4 v9, s[12:15], s66 offen offset:1024  lds
    buffer_load_dwordx4 v10, s[12:15], s66 offen offset:2048  lds
    buffer_load_dwordx4 v11, s[12:15], s66 offen offset:3072  lds
    s_add_u32 s66, s66, 131072
    s_and_b32 s66, s66, 0x1fffff
    s_add_u32 m0, s64, 0
    s_nop 0
    buffer_load_dwordx4 v12, s[8:11], s67 offen offset:0  lds
    buffer_load_dwordx4 v13, s[8:11], s67 offen offset:1024  lds
    buffer_load_dwordx4 v14, s[8:11], s67 offen offset:2048  lds
    buffer_load_dwordx4 v15, s[8:11], s67 offen offset:3072  lds
    s_add_u32 s67, s67, 128
    s_and_b32 s67, s67, 2047
    buffer_load_dword v19, v20, s[56:59], 0 offen sc1
    v_mov_b32 v17, s3
    v_lshlrev_b32 v17, 7, v17
    v_lshlrev_b32 v16, 4, v2
    s_lshl_b32 s71, s62, 13
    v_add_u32 v16, s71, v16
    s_lshl_b32 s73, s3, 18
    s_waitcnt vmcnt(9)
    s_barrier
    s_barrier
    s_add_u32 m0, s63, 32768
    s_nop 0
    buffer_load_dwordx4 v8, s[12:15], s66 offen offset:0  lds
    buffer_load_dwordx4 v9, s[12:15], s66 offen offset:1024  lds
    buffer_load_dwordx4 v10, s[12:15], s66 offen offset:2048  lds
    buffer_load_dwordx4 v11, s[12:15], s66 offen offset:3072  lds
    s_add_u32 s66, s66, 131072
    s_and_b32 s66, s66, 0x1fffff
    s_add_u32 m0, s64, 32768
    s_nop 0
    buffer_load_dwordx4 v12, s[8:11], s67 offen offset:0  lds
    buffer_load_dwordx4 v13, s[8:11], s67 offen offset:1024  lds
    buffer_load_dwordx4 v14, s[8:11], s67 offen offset:2048  lds
    buffer_load_dwordx4 v15, s[8:11], s67 offen offset:3072  lds
    s_add_u32 s67, s67, 128
    s_and_b32 s67, s67, 2047
    s_barrier
    s_add_u32 m0, s63, 65536
    s_nop 0
    buffer_load_dwordx4 v8, s[12:15], s66 offen offset:0  lds
    buffer_load_dwordx4 v9, s[12:15], s66 offen offset:1024  lds
    buffer_load_dwordx4 v10, s[12:15], s66 offen offset:2048  lds
    buffer_load_dwordx4 v11, s[12:15], s66 offen offset:3072  lds
    s_add_u32 s66, s66, 131072
    s_and_b32 s66, s66, 0x1fffff
    s_add_u32 m0, s64, 65536
    s_nop 0
    buffer_load_dwordx4 v12, s[8:11], s67 offen offset:0  lds
    buffer_load_dwordx4 v13, s[8:11], s67 offen offset:1024  lds
    buffer_load_dwordx4 v14, s[8:11], s67 offen offset:2048  lds
    buffer_load_dwordx4 v15, s[8:11], s67 offen offset:3072  lds
    s_add_u32 s67, s67, 128
    s_and_b32 s67, s67, 2047
    s_add_u32 m0, s63, 98304
    s_nop 0
    buffer_load_dwordx4 v8, s[12:15], s66 offen offset:0  lds
    buffer_load_dwordx4 v9, s[12:15], s66 offen offset:1024  lds
    buffer_load_dwordx4 v10, s[12:15], s66 offen offset:2048  lds
    buffer_load_dwordx4 v11, s[12:15], s66 offen offset:3072  lds
    s_add_u32 s66, s66, 131072
    s_and_b32 s66, s66, 0x1fffff
    s_add_u32 m0, s64, 98304
    s_nop 0
    buffer_load_dwordx4 v12, s[8:11], s67 offen offset:0  lds
    buffer_load_dwordx4 v13, s[8:11], s67 offen offset:1024  lds
    buffer_load_dwordx4 v14, s[8:11], s67 offen offset:2048  lds
    buffer_load_dwordx4 v15, s[8:11], s67 offen offset:3072  lds
    s_add_u32 s67, s67, 128
    s_and_b32 s67, s67, 2047
    s_waitcnt vmcnt(24)
    s_barrier
    s_waitcnt vmcnt(16)
    s_barrier
    s_cmp_ge_u32 s62, 2
    s_cbranch_scc1 L_l_dummy
    s_lshl_b32 s60, s62, 11
    s_add_u32 s60, s60, 131072
    v_lshlrev_b32 v24, 4, v2
    v_add_u32 v25, s60, v24
    ds_read_b128 v[40:43], v25 offset:0
    ds_read_b128 v[44:47], v25 offset:1024
    ds_read_b128 v[48:51], v25 offset:4096
    ds_read_b128 v[52:55], v25 offset:5120
    ds_read_b128 v[56:59], v25 offset:8192
    ds_read_b128 v[60:63], v25 offset:9216
    ds_read_b128 v[64:67], v25 offset:12288
    ds_read_b128 v[68:71], v25 offset:13312
    s_waitcnt lgkmcnt(4)
    ds_read_b128 v[72:75], v25 offset:16384
    ds_read_b128 v[76:79], v25 offset:17408
    ds_read_b128 v[80:83], v25 offset:20480
    ds_read_b128 v[84:87], v25 offset:21504
    ds_read_b128 v[88:91], v25 offset:24576
    ds_read_b128 v[92:95], v25 offset:25600
    ds_read_b128 v[96:99], v25 offset:28672
    ds_read_b128 v[100:103], v25 offset:29696
    s_waitcnt lgkmcnt(0)
    v_add_f32 v40, v40, v48
    v_add_f32 v41, v41, v49
    v_add_f32 v42, v42, v50
    v_add_f32 v43, v43, v51
    v_add_f32 v44, v44, v52
    v_add_f32 v45, v45, v53
    v_add_f32 v46, v46, v54
    v_add_f32 v47, v47, v55
    v_add_f32 v40, v40, v56
    v_add_f32 v41, v41, v57
    v_add_f32 v42, v42, v58
    v_add_f32 v43, v43, v59
    v_add_f32 v44, v44, v60
    v_add_f32 v45, v45, v61
    v_add_f32 v46, v46, v62
    v_add_f32 v47, v47, v63
    v_add_f32 v40, v40, v64
    v_add_f32 v41, v41, v65
    v_add_f32 v42, v42, v66
    v_add_f32 v43, v43, v67
    v_add_f32 v44, v44, v68
    v_add_f32 v45, v45, v69
    v_add_f32 v46, v46, v70
    v_add_f32 v47, v47, v71
    v_add_f32 v40, v40, v72
    v_add_f32 v41, v41, v73
    v_add_f32 v42, v42, v74
    v_add_f32 v43, v43, v75
    v_add_f32 v44, v44, v76
    v_add_f32 v45, v45, v77
    v_add_f32 v46, v46, v78
    v_add_f32 v47, v47, v79
    v_add_f32 v40, v40, v80
    v_add_f32 v41, v41, v81
    v_add_f32 v42, v42, v82
    v_add_f32 v43, v43, v83
    v_add_f32 v44, v44, v84
    v_add_f32 v45, v45, v85
    v_add_f32 v46, v46, v86
    v_add_f32 v47, v47, v87
    v_add_f32 v40, v40, v88
    v_add_f32 v41, v41, v89
    v_add_f32 v42, v42, v90
    v_add_f32 v43, v43, v91
    v_add_f32 v44, v44, v92
    v_add_f32 v45, v45, v93
    v_add_f32 v46, v46, v94
    v_add_f32 v47, v47, v95
    v_add_f32 v40, v40, v96
    v_add_f32 v41, v41, v97
    v_add_f32 v42, v42, v98
    v_add_f32 v43, v43, v99
    v_add_f32 v44, v44, v100
    v_add_f32 v45, v45, v101
    v_add_f32 v46, v46, v102
    v_add_f32 v47, v47, v103
    s_and_b32 s60, s5, 1
    s_cmp_eq_u32 s60, 0
    s_cselect_b32 s60, 0x3e8293ee, 1.0
    v_mul_f32 v40, s60, v40
    v_mul_f32 v41, s60, v41
    v_mul_f32 v42, s60, v42
    v_mul_f32 v43, s60, v43
    v_mul_f32 v44, s60, v44
    v_mul_f32 v45, s60, v45
    v_mul_f32 v46, s60, v46
    v_mul_f32 v47, s60, v47
    v_cvt_pk_bf16_f32 v36, v40, v41
    v_cvt_pk_bf16_f32 v37, v42, v43
    v_cvt_pk_bf16_f32 v38, v44, v45
    v_cvt_pk_bf16_f32 v39, v46, v47
    s_and_b32 s60, s5, 1
    s_cmp_eq_u32 s60, 0
    s_cbranch_scc0 L_l_nokswap
    s_nop 1
    v_permlane32_swap_b32 v36, v38
    v_permlane32_swap_b32 v37, v39
    s_nop 1
L_l_nokswap:
    s_lshr_b32 s60, s5, 1
    s_lshl_b32 s65, s4, 2
    s_add_u32 s60, s60, s65
    s_lshl_b32 s60, s60, 12
    s_and_b32 s65, s5, 1
    s_lshl_b32 s65, s65, 11
    s_add_u32 s60, s60, s65
    s_lshl_b32 s65, s62, 10
    s_add_u32 s60, s60, s65
    s_lshl_b32 s65, s3, 18
    s_add_u32 s60, s60, s65
    buffer_store_dwordx4 v[36:39], v24, s[56:59], s60 offen sc1
    s_branch L_l_red_done
L_l_dummy:
    buffer_load_dword v36, v20, s[56:59], 0 offen sc1
L_l_red_done:
    s_waitcnt vmcnt(9)
    s_barrier
    s_add_u32 m0, s63, 131072
    s_nop 0
    buffer_load_dwordx4 v8, s[12:15], s66 offen offset:0  lds
    buffer_load_dwordx4 v9, s[12:15], s66 offen offset:1024  lds
    buffer_load_dwordx4 v10, s[12:15], s66 offen offset:2048  lds
    buffer_load_dwordx4 v11, s[12:15], s66 offen offset:3072  lds
    s_add_u32 s66, s66, 131072
    s_and_b32 s66, s66, 0x1fffff
    s_add_u32 m0, s64, 131072
    s_nop 0
    buffer_load_dwordx4 v12, s[8:11], s67 offen offset:0  lds
    buffer_load_dwordx4 v13, s[8:11], s67 offen offset:1024  lds
    buffer_load_dwordx4 v14, s[8:11], s67 offen offset:2048  lds
    buffer_load_dwordx4 v15, s[8:11], s67 offen offset:3072  lds
    s_add_u32 s67, s67, 128
    s_and_b32 s67, s67, 2047
    s_add_u32 m0, s63, 0
    s_nop 0
    buffer_load_dwordx4 v8, s[12:15], s66 offen offset:0  lds
    buffer_load_dwordx4 v9, s[12:15], s66 offen offset:1024  lds
    buffer_load_dwordx4 v10, s[12:15], s66 offen offset:2048  lds
    buffer_load_dwordx4 v11, s[12:15], s66 offen offset:3072  lds
    s_add_u32 s66, s66, 131072
    s_and_b32 s66, s66, 0x1fffff
    s_add_u32 m0, s64, 0
    s_nop 0
    buffer_load_dwordx4 v12, s[8:11], s67 offen offset:0  lds
    buffer_load_dwordx4 v13, s[8:11], s67 offen offset:1024  lds
    buffer_load_dwordx4 v14, s[8:11], s67 offen offset:2048  lds
    buffer_load_dwordx4 v15, s[8:11], s67 offen offset:3072  lds
    s_add_u32 s67, s67, 128
    s_and_b32 s67, s67, 2047
    s_waitcnt vmcnt(17)
    s_barrier
    s_add_u32 m0, s63, 32768
    s_nop 0
    buffer_load_dwordx4 v8, s[12:15], s66 offen offset:0  lds
    buffer_load_dwordx4 v9, s[12:15], s66 offen offset:1024  lds
    buffer_load_dwordx4 v10, s[12:15], s66 offen offset:2048  lds
    buffer_load_dwordx4 v11, s[12:15], s66 offen offset:3072  lds
    s_add_u32 s66, s66, 131072
    s_and_b32 s66, s66, 0x1fffff
    s_add_u32 m0, s64, 32768
    s_nop 0
    buffer_load_dwordx4 v12, s[8:11], s67 offen offset:0  lds
    buffer_load_dwordx4 v13, s[8:11], s67 offen offset:1024  lds
    buffer_load_dwordx4 v14, s[8:11], s67 offen offset:2048  lds
    buffer_load_dwordx4 v15, s[8:11], s67 offen offset:3072  lds
    s_add_u32 s67, s67, 128
    s_and_b32 s67, s67, 2047
    s_waitcnt vmcnt(16)
    s_barrier
    s_add_u32 m0, s63, 65536
    s_nop 0
    buffer_load_dwordx4 v8, s[12:15], s66 offen offset:0  lds
    buffer_load_dwordx4 v9, s[12:15], s66 offen offset:1024  lds
    buffer_load_dwordx4 v10, s[12:15], s66 offen offset:2048  lds
    buffer_load_dwordx4 v11, s[12:15], s66 offen offset:3072  lds
    s_add_u32 s66, s66, 131072
    s_and_b32 s66, s66, 0x1fffff
    s_add_u32 m0, s64, 65536
    s_nop 0
    buffer_load_dwordx4 v12, s[8:11], s67 offen offset:0  lds
    buffer_load_dwordx4 v13, s[8:11], s67 offen offset:1024  lds
    buffer_load_dwordx4 v14, s[8:11], s67 offen offset:2048  lds
    buffer_load_dwordx4 v15, s[8:11], s67 offen offset:3072  lds
    s_add_u32 s67, s67, 128
    s_and_b32 s67, s67, 2047
    s_cmp_eq_u32 s62, 0
    s_cbranch_scc0 L_l_nosig
    s_mov_b64 exec, 1
    v_mov_b32 v24, 1
    global_atomic_add v17, v24, s[36:37]
    s_mov_b64 exec, -1
L_l_nosig:
    s_waitcnt vmcnt(16)
    s_barrier
    s_add_u32 m0, s63, 98304
    s_nop 0
    buffer_load_dwordx4 v8, s[12:15], s66 offen offset:0  lds
    buffer_load_dwordx4 v9, s[12:15], s66 offen offset:1024  lds
    buffer_load_dwordx4 v10, s[12:15], s66 offen offset:2048  lds
    buffer_load_dwordx4 v11, s[12:15], s66 offen offset:3072  lds
    s_add_u32 s66, s66, 131072
    s_and_b32 s66, s66, 0x1fffff
    s_add_u32 m0, s64, 98304
    s_nop 0
    buffer_load_dwordx4 v12, s[8:11], s67 offen offset:0  lds
    buffer_load_dwordx4 v13, s[8:11], s67 offen offset:1024  lds
    buffer_load_dwordx4 v14, s[8:11], s67 offen offset:2048  lds
    buffer_load_dwordx4 v15, s[8:11], s67 offen offset:3072  lds
    s_add_u32 s67, s67, 128
    s_and_b32 s67, s67, 2047
    s_waitcnt vmcnt(16)
    s_barrier
    s_add_u32 m0, s63, 131072
    s_nop 0
    buffer_load_dwordx4 v8, s[12:15], s66 offen offset:0  lds
    buffer_load_dwordx4 v9, s[12:15], s66 offen offset:1024  lds
    buffer_load_dwordx4 v10, s[12:15], s66 offen offset:2048  lds
    buffer_load_dwordx4 v11, s[12:15], s66 offen offset:3072  lds
    s_add_u32 s66, s66, 131072
    s_and_b32 s66, s66, 0x1fffff
    s_add_u32 m0, s64, 131072
    s_nop 0
    buffer_load_dwordx4 v12, s[8:11], s67 offen offset:0  lds
    buffer_load_dwordx4 v13, s[8:11], s67 offen offset:1024  lds
    buffer_load_dwordx4 v14, s[8:11], s67 offen offset:2048  lds
    buffer_load_dwordx4 v15, s[8:11], s67 offen offset:3072  lds
    s_add_u32 s67, s67, 128
    s_and_b32 s67, s67, 2047
    s_waitcnt vmcnt(16)
    s_barrier
    s_add_u32 m0, s63, 0
    s_nop 0
    buffer_load_dwordx4 v8, s[12:15], s66 offen offset:0  lds
    buffer_load_dwordx4 v9, s[12:15], s66 offen offset:1024  lds
    buffer_load_dwordx4 v10, s[12:15], s66 offen offset:2048  lds
    buffer_load_dwordx4 v11, s[12:15], s66 offen offset:3072  lds
    s_add_u32 s66, s66, 131072
    s_and_b32 s66, s66, 0x1fffff
    s_add_u32 m0, s64, 0
    s_nop 0
    buffer_load_dwordx4 v12, s[8:11], s67 offen offset:0  lds
    buffer_load_dwordx4 v13, s[8:11], s67 offen offset:1024  lds
    buffer_load_dwordx4 v14, s[8:11], s67 offen offset:2048  lds
    buffer_load_dwordx4 v15, s[8:11], s67 offen offset:3072  lds
    s_add_u32 s67, s67, 128
    s_and_b32 s67, s67, 2047
    s_waitcnt vmcnt(16)
    s_barrier
    s_add_u32 m0, s63, 32768
    s_nop 0
    buffer_load_dwordx4 v8, s[12:15], s66 offen offset:0  lds
    buffer_load_dwordx4 v9, s[12:15], s66 offen offset:1024  lds
    buffer_load_dwordx4 v10, s[12:15], s66 offen offset:2048  lds
    buffer_load_dwordx4 v11, s[12:15], s66 offen offset:3072  lds
    s_add_u32 s66, s66, 131072
    s_and_b32 s66, s66, 0x1fffff
    s_add_u32 m0, s64, 32768
    s_nop 0
    buffer_load_dwordx4 v12, s[8:11], s67 offen offset:0  lds
    buffer_load_dwordx4 v13, s[8:11], s67 offen offset:1024  lds
    buffer_load_dwordx4 v14, s[8:11], s67 offen offset:2048  lds
    buffer_load_dwordx4 v15, s[8:11], s67 offen offset:3072  lds
    s_add_u32 s67, s67, 128
    s_and_b32 s67, s67, 2047
    s_waitcnt vmcnt(16)
    s_barrier
    s_add_u32 m0, s63, 65536
    s_nop 0
    buffer_load_dwordx4 v8, s[12:15], s66 offen offset:0  lds
    buffer_load_dwordx4 v9, s[12:15], s66 offen offset:1024  lds
    buffer_load_dwordx4 v10, s[12:15], s66 offen offset:2048  lds
    buffer_load_dwordx4 v11, s[12:15], s66 offen offset:3072  lds
    s_add_u32 s66, s66, 131072
    s_and_b32 s66, s66, 0x1fffff
    s_add_u32 m0, s64, 65536
    s_nop 0
    buffer_load_dwordx4 v12, s[8:11], s67 offen offset:0  lds
    buffer_load_dwordx4 v13, s[8:11], s67 offen offset:1024  lds
    buffer_load_dwordx4 v14, s[8:11], s67 offen offset:2048  lds
    buffer_load_dwordx4 v15, s[8:11], s67 offen offset:3072  lds
    s_add_u32 s67, s67, 128
    s_and_b32 s67, s67, 2047
    s_waitcnt vmcnt(16)
    s_barrier
    s_add_u32 m0, s63, 98304
    s_nop 0
    buffer_load_dwordx4 v8, s[12:15], s66 offen offset:0  lds
    buffer_load_dwordx4 v9, s[12:15], s66 offen offset:1024  lds
    buffer_load_dwordx4 v10, s[12:15], s66 offen offset:2048  lds
    buffer_load_dwordx4 v11, s[12:15], s66 offen offset:3072  lds
    s_add_u32 s66, s66, 131072
    s_and_b32 s66, s66, 0x1fffff
    s_add_u32 m0, s64, 98304
    s_nop 0
    buffer_load_dwordx4 v12, s[8:11], s67 offen offset:0  lds
    buffer_load_dwordx4 v13, s[8:11], s67 offen offset:1024  lds
    buffer_load_dwordx4 v14, s[8:11], s67 offen offset:2048  lds
    buffer_load_dwordx4 v15, s[8:11], s67 offen offset:3072  lds
    s_add_u32 s67, s67, 128
    s_and_b32 s67, s67, 2047
    s_cmp_eq_u32 s62, 0
    s_cbranch_scc0 L_l_kvdummy
    global_load_dword v18, v17, s[36:37] sc1
    s_branch L_l_kvpolled
L_l_kvdummy:
    buffer_load_dword v18, v16, s[12:15], 0 offen
L_l_kvpolled:
    s_waitcnt vmcnt(17)
    s_barrier
    s_add_u32 m0, s63, 131072
    s_nop 0
    buffer_load_dwordx4 v8, s[12:15], s66 offen offset:0  lds
    buffer_load_dwordx4 v9, s[12:15], s66 offen offset:1024  lds
    buffer_load_dwordx4 v10, s[12:15], s66 offen offset:2048  lds
    buffer_load_dwordx4 v11, s[12:15], s66 offen offset:3072  lds
    s_add_u32 s66, s66, 131072
    s_and_b32 s66, s66, 0x1fffff
    s_add_u32 m0, s64, 131072
    s_nop 0
    buffer_load_dwordx4 v12, s[8:11], s67 offen offset:0  lds
    buffer_load_dwordx4 v13, s[8:11], s67 offen offset:1024  lds
    buffer_load_dwordx4 v14, s[8:11], s67 offen offset:2048  lds
    buffer_load_dwordx4 v15, s[8:11], s67 offen offset:3072  lds
    s_add_u32 s67, s67, 128
    s_and_b32 s67, s67, 2047
    s_waitcnt vmcnt(17)
    s_barrier
    s_add_u32 m0, s63, 0
    s_nop 0
    buffer_load_dwordx4 v8, s[12:15], s66 offen offset:0  lds
    buffer_load_dwordx4 v9, s[12:15], s66 offen offset:1024  lds
    buffer_load_dwordx4 v10, s[12:15], s66 offen offset:2048  lds
    buffer_load_dwordx4 v11, s[12:15], s66 offen offset:3072  lds
    s_add_u32 s66, s66, 131072
    s_and_b32 s66, s66, 0x1fffff
    s_add_u32 m0, s64, 0
    s_nop 0
    buffer_load_dwordx4 v12, s[8:11], s67 offen offset:0  lds
    buffer_load_dwordx4 v13, s[8:11], s67 offen offset:1024  lds
    buffer_load_dwordx4 v14, s[8:11], s67 offen offset:2048  lds
    buffer_load_dwordx4 v15, s[8:11], s67 offen offset:3072  lds
    s_add_u32 s67, s67, 128
    s_and_b32 s67, s67, 2047
    s_waitcnt vmcnt(16)
    s_cmp_eq_u32 s62, 0
    s_cbranch_scc0 L_l_kvok
    v_readfirstlane_b32 s60, v18
    s_mov_b32 s65, 0x2000
    s_nop 2
    s_cmp_ge_u32 s60, 128
    s_cbranch_scc1 L_l_kvok
L_l_kvpoll:
    s_sleep 32
    global_load_dword v18, v17, s[36:37] sc1
    s_waitcnt vmcnt(0)
    v_readfirstlane_b32 s60, v18
    s_nop 3
    s_cmp_ge_u32 s60, 128
    s_cbranch_scc1 L_l_kvok
    s_sub_u32 s65, s65, 1
    s_cmp_lg_u32 s65, 0
    s_cbranch_scc1 L_l_kvpoll
L_l_kvok:
    s_barrier
    s_add_u32 m0, s71, 32768
    s_nop 0
    buffer_load_dwordx4 v16, s[56:59], s73 offen offset:0 sc1 lds
    buffer_load_dwordx4 v16, s[56:59], s73 offen offset:1024 sc1 lds
    buffer_load_dwordx4 v16, s[56:59], s73 offen offset:2048 sc1 lds
    buffer_load_dwordx4 v16, s[56:59], s73 offen offset:3072 sc1 lds
    s_add_u32 m0, m0, 4096
    s_add_u32 s60, s73, 4096
    buffer_load_dwordx4 v16, s[56:59], s60 offen offset:0 sc1 lds
    buffer_load_dwordx4 v16, s[56:59], s60 offen offset:1024 sc1 lds
    buffer_load_dwordx4 v16, s[56:59], s60 offen offset:2048 sc1 lds
    buffer_load_dwordx4 v16, s[56:59], s60 offen offset:3072 sc1 lds
    s_add_u32 s73, s73, 32768
    s_waitcnt vmcnt(16)
    s_barrier
    s_add_u32 m0, s71, 65536
    s_nop 0
    buffer_load_dwordx4 v16, s[56:59], s73 offen offset:0 sc1 lds
    buffer_load_dwordx4 v16, s[56:59], s73 offen offset:1024 sc1 lds
    buffer_load_dwordx4 v16, s[56:59], s73 offen offset:2048 sc1 lds
    buffer_load_dwordx4 v16, s[56:59], s73 offen offset:3072 sc1 lds
    s_add_u32 m0, m0, 4096
    s_add_u32 s60, s73, 4096
    buffer_load_dwordx4 v16, s[56:59], s60 offen offset:0 sc1 lds
    buffer_load_dwordx4 v16, s[56:59], s60 offen offset:1024 sc1 lds
    buffer_load_dwordx4 v16, s[56:59], s60 offen offset:2048 sc1 lds
    buffer_load_dwordx4 v16, s[56:59], s60 offen offset:3072 sc1 lds
    s_add_u32 s73, s73, 32768
    s_waitcnt vmcnt(16)
    s_barrier
    s_add_u32 m0, s71, 98304
    s_nop 0
    buffer_load_dwordx4 v16, s[56:59], s73 offen offset:0 sc1 lds
    buffer_load_dwordx4 v16, s[56:59], s73 offen offset:1024 sc1 lds
    buffer_load_dwordx4 v16, s[56:59], s73 offen offset:2048 sc1 lds
    buffer_load_dwordx4 v16, s[56:59], s73 offen offset:3072 sc1 lds
    s_add_u32 m0, m0, 4096
    s_add_u32 s60, s73, 4096
    buffer_load_dwordx4 v16, s[56:59], s60 offen offset:0 sc1 lds
    buffer_load_dwordx4 v16, s[56:59], s60 offen offset:1024 sc1 lds
    buffer_load_dwordx4 v16, s[56:59], s60 offen offset:2048 sc1 lds
    buffer_load_dwordx4 v16, s[56:59], s60 offen offset:3072 sc1 lds
    s_add_u32 s73, s73, 32768
    s_mov_b32 s12, s48
    s_and_b32 s13, s49, 0xffff
    s_mov_b32 s14, 0x200000
    s_mov_b32 s15, 0x00020000
    s_mov_b32 s8, s52
    s_and_b32 s9, s53, 0xffff
    s_mov_b32 s10, 0x10000000
    s_mov_b32 s11, 0x00020000
    s_lshl_b32 s60, s62, 16
    s_lshl_b32 s65, s3, 22
    s_add_u32 s60, s60, s65
    s_lshl_b32 s65, s4, 18
    s_add_u32 s60, s60, s65
    s_add_u32 s60, s60, 1048576
    v_lshlrev_b32 v24, 4, v2
    v_add_u32 v12, s60, v24
    s_lshl_b32 s66, s5, 18
    s_lshl_b32 s67, s5, 13
    s_add_u32 s67, s67, 8192
    s_and_b32 s67, s67, 65535
    v_lshrrev_b32 v25, 1, v2
    s_and_b32 s60, s4, 3
    s_lshl_b32 s60, s60, 8
    s_lshl_b32 s65, s62, 6
    s_add_u32 s60, s60, s65
    v_add_u32 v25, s60, v25
    v_lshlrev_b32 v25, 11, v25
    v_and_b32 v26, 1, v2
    v_lshl_add_u32 v25, v26, 7, v25
    s_lshl_b32 s60, s5, 8
    v_add_u32 v25, s60, v25
    s_waitcnt vmcnt(16)
    s_barrier
    s_waitcnt vmcnt(8)
    s_barrier
    s_add_u32 m0, s71, 32768
    s_nop 0
    buffer_load_dwordx4 v16, s[56:59], s73 offen offset:0 sc1 lds
    buffer_load_dwordx4 v16, s[56:59], s73 offen offset:1024 sc1 lds
    buffer_load_dwordx4 v16, s[56:59], s73 offen offset:2048 sc1 lds
    buffer_load_dwordx4 v16, s[56:59], s73 offen offset:3072 sc1 lds
    s_add_u32 m0, m0, 4096
    s_add_u32 s60, s73, 4096
    buffer_load_dwordx4 v16, s[56:59], s60 offen offset:0 sc1 lds
    buffer_load_dwordx4 v16, s[56:59], s60 offen offset:1024 sc1 lds
    buffer_load_dwordx4 v16, s[56:59], s60 offen offset:2048 sc1 lds
    buffer_load_dwordx4 v16, s[56:59], s60 offen offset:3072 sc1 lds
    s_add_u32 s73, s73, 32768
    buffer_load_dword v18, v25, s[12:15], 0 offen
    s_mov_b32 s60, 65536
    buffer_load_dword v18, v25, s[12:15], s60 offen
    s_waitcnt vmcnt(8)
    s_barrier
    s_add_u32 m0, s71, 65536
    s_nop 0
    buffer_load_dwordx4 v16, s[56:59], s73 offen offset:0 sc1 lds
    buffer_load_dwordx4 v16, s[56:59], s73 offen offset:1024 sc1 lds
    buffer_load_dwordx4 v16, s[56:59], s73 offen offset:2048 sc1 lds
    buffer_load_dwordx4 v16, s[56:59], s73 offen offset:3072 sc1 lds
    s_add_u32 m0, m0, 4096
    s_add_u32 s60, s73, 4096
    buffer_load_dwordx4 v16, s[56:59], s60 offen offset:0 sc1 lds
    buffer_load_dwordx4 v16, s[56:59], s60 offen offset:1024 sc1 lds
    buffer_load_dwordx4 v16, s[56:59], s60 offen offset:2048 sc1 lds
    buffer_load_dwordx4 v16, s[56:59], s60 offen offset:3072 sc1 lds
    s_add_u32 s73, s73, 32768
    s_waitcnt vmcnt(8)
    s_barrier
    s_add_u32 m0, s71, 98304
    s_nop 0
    buffer_load_dwordx4 v16, s[56:59], s73 offen offset:0 sc1 lds
    buffer_load_dwordx4 v16, s[56:59], s73 offen offset:1024 sc1 lds
    buffer_load_dwordx4 v16, s[56:59], s73 offen offset:2048 sc1 lds
    buffer_load_dwordx4 v16, s[56:59], s73 offen offset:3072 sc1 lds
    s_add_u32 m0, m0, 4096
    s_add_u32 s60, s73, 4096
    buffer_load_dwordx4 v16, s[56:59], s60 offen offset:0 sc1 lds
    buffer_load_dwordx4 v16, s[56:59], s60 offen offset:1024 sc1 lds
    buffer_load_dwordx4 v16, s[56:59], s60 offen offset:2048 sc1 lds
    buffer_load_dwordx4 v16, s[56:59], s60 offen offset:3072 sc1 lds
    s_add_u32 s73, s73, 32768
    s_waitcnt vmcnt(8)
    s_barrier
    s_add_u32 m0, s71, 32768
    s_nop 0
    buffer_load_dwordx4 v16, s[56:59], s73 offen offset:0 sc1 lds
    buffer_load_dwordx4 v16, s[56:59], s73 offen offset:1024 sc1 lds
    buffer_load_dwordx4 v16, s[56:59], s73 offen offset:2048 sc1 lds
    buffer_load_dwordx4 v16, s[56:59], s73 offen offset:3072 sc1 lds
    s_add_u32 m0, m0, 4096
    s_add_u32 s60, s73, 4096
    buffer_load_dwordx4 v16, s[56:59], s60 offen offset:0 sc1 lds
    buffer_load_dwordx4 v16, s[56:59], s60 offen offset:1024 sc1 lds
    buffer_load_dwordx4 v16, s[56:59], s60 offen offset:2048 sc1 lds
    buffer_load_dwordx4 v16, s[56:59], s60 offen offset:3072 sc1 lds
    s_add_u32 s73, s73, 32768
    s_waitcnt vmcnt(8)
    s_barrier
    s_add_u32 m0, s71, 65536
    s_nop 0
    buffer_load_dwordx4 v16, s[56:59], s73 offen offset:0 sc1 lds
    buffer_load_dwordx4 v16, s[56:59], s73 offen offset:1024 sc1 lds
    buffer_load_dwordx4 v16, s[56:59], s73 offen offset:2048 sc1 lds
    buffer_load_dwordx4 v16, s[56:59], s73 offen offset:3072 sc1 lds
    s_add_u32 m0, m0, 4096
    s_add_u32 s60, s73, 4096
    buffer_load_dwordx4 v16, s[56:59], s60 offen offset:0 sc1 lds
    buffer_load_dwordx4 v16, s[56:59], s60 offen offset:1024 sc1 lds
    buffer_load_dwordx4 v16, s[56:59], s60 offen offset:2048 sc1 lds
    buffer_load_dwordx4 v16, s[56:59], s60 offen offset:3072 sc1 lds
    s_add_u32 s73, s73, 32768
    s_waitcnt vmcnt(8)
    s_barrier
    s_add_u32 m0, s63, 131072
    s_nop 0
    buffer_load_dwordx4 v8, s[12:15], s66 offen offset:0  lds
    buffer_load_dwordx4 v9, s[12:15], s66 offen offset:1024  lds
    buffer_load_dwordx4 v10, s[12:15], s66 offen offset:2048  lds
    buffer_load_dwordx4 v11, s[12:15], s66 offen offset:3072  lds
    s_add_u32 s66, s66, 131072
    s_and_b32 s66, s66, 0x1fffff
    s_add_u32 m0, s63, 0
    s_nop 0
    buffer_load_dwordx4 v8, s[12:15], s66 offen offset:0  lds
    buffer_load_dwordx4 v9, s[12:15], s66 offen offset:1024  lds
    buffer_load_dwordx4 v10, s[12:15], s66 offen offset:2048  lds
    buffer_load_dwordx4 v11, s[12:15], s66 offen offset:3072  lds
    s_add_u32 s66, s66, 131072
    s_and_b32 s66, s66, 0x1fffff
    s_waitcnt vmcnt(8)
    s_barrier
    s_add_u32 m0, s63, 32768
    s_nop 0
    buffer_load_dwordx4 v8, s[12:15], s66 offen offset:0  lds
    buffer_load_dwordx4 v9, s[12:15], s66 offen offset:1024  lds
    buffer_load_dwordx4 v10, s[12:15], s66 offen offset:2048  lds
    buffer_load_dwordx4 v11, s[12:15], s66 offen offset:3072  lds
    s_add_u32 s66, s66, 131072
    s_and_b32 s66, s66, 0x1fffff
    s_lshl_b32 s60, s62, 12
    s_add_u32 s60, s60, 49152
    v_mov_b32 v26, s60
    v_mov_b32 v27, 0
    ds_write_b32 v26, v27
    v_add_u32 v26, 65536, v26
    ds_write_b32 v26, v27
    s_movk_i32 s79, 0x5a5a
    s_waitcnt lgkmcnt(0)
    s_waitcnt vmcnt(0)
    s_barrier
    v_add_u32 v19, 1, v19
    s_cmp_eq_u32 s62, 0
    s_cbranch_scc0 L_l_noflag
    v_cmp_eq_u32 vcc, s5, v2
    s_nop 4
    s_mov_b64 exec, vcc
    buffer_store_dword v19, v20, s[56:59], 0 offen sc1
    s_mov_b64 exec, -1
L_l_noflag:
    s_add_u32 m0, s63, 65536
    s_nop 0
    buffer_load_dwordx4 v8, s[12:15], s66 offen offset:0  lds
    buffer_load_dwordx4 v9, s[12:15], s66 offen offset:1024  lds
    buffer_load_dwordx4 v10, s[12:15], s66 offen offset:2048  lds
    buffer_load_dwordx4 v11, s[12:15], s66 offen offset:3072  lds
    s_add_u32 s66, s66, 131072
    s_and_b32 s66, s66, 0x1fffff
    s_lshl_b32 s60, s62, 12
    s_add_u32 s60, s60, 49152
    v_mov_b32 v26, s60
    s_cmp_eq_u32 s62, 0
    s_cbranch_scc1 L_l_o1poll0
L_l_o1mb:
    ds_read_b32 v27, v26
    s_waitcnt lgkmcnt(0)
    v_readfirstlane_b32 s60, v27
    s_nop 3
    s_cmp_eq_u32 s60, s79
    s_cbranch_scc1 L_l_o1go
    s_sleep 1
    s_branch L_l_o1mb
L_l_o1poll0:
    s_mov_b32 s65, 0x8000
L_l_o1poll:
    buffer_load_dword v18, v20, s[56:59], 0 offen sc1
    s_waitcnt vmcnt(0)
    v_cmp_eq_u32 vcc, v18, v19
    s_nop 4
    s_cmp_eq_u64 vcc, -1
    s_cbranch_scc1 L_l_o1set
    s_sleep 2
    s_sub_u32 s65, s65, 1
    s_cmp_lg_u32 s65, 0
    s_cbranch_scc1 L_l_o1poll
L_l_o1set:
    v_mov_b32 v27, s79
    ds_write_b32 v26, v27 offset:4096
    ds_write_b32 v26, v27 offset:8192
    ds_write_b32 v26, v27 offset:12288
    s_waitcnt lgkmcnt(0)
L_l_o1go:
    s_add_u32 m0, s64, 32768
    s_nop 0
    buffer_load_dwordx4 v12, s[8:11], s67 offen offset:0 sc1 lds
    buffer_load_dwordx4 v12, s[8:11], s67 offen offset:1024 sc1 lds
    buffer_load_dwordx4 v12, s[8:11], s67 offen offset:2048 sc1 lds
    buffer_load_dwordx4 v12, s[8:11], s67 offen offset:3072 sc1 lds
    s_add_u32 s67, s67, 4096
    s_and_b32 s67, s67, 65535
    s_add_u32 m0, s64, 65536
    s_nop 0
    buffer_load_dwordx4 v12, s[8:11], s67 offen offset:0 sc1 lds
    buffer_load_dwordx4 v12, s[8:11], s67 offen offset:1024 sc1 lds
    buffer_load_dwordx4 v12, s[8:11], s67 offen offset:2048 sc1 lds
    buffer_load_dwordx4 v12, s[8:11], s67 offen offset:3072 sc1 lds
    s_add_u32 s67, s67, 4096
    s_and_b32 s67, s67, 65535
    s_add_u32 m0, s64, 98304
    s_nop 0
    buffer_load_dwordx4 v12, s[8:11], s67 offen offset:0 sc1 lds
    buffer_load_dwordx4 v12, s[8:11], s67 offen offset:1024 sc1 lds
    buffer_load_dwordx4 v12, s[8:11], s67 offen offset:2048 sc1 lds
    buffer_load_dwordx4 v12, s[8:11], s67 offen offset:3072 sc1 lds
    s_add_u32 s67, s67, 4096
    s_and_b32 s67, s67, 65535
    s_add_u32 m0, s63, 98304
    s_nop 0
    buffer_load_dwordx4 v8, s[12:15], s66 offen offset:0  lds
    buffer_load_dwordx4 v9, s[12:15], s66 offen offset:1024  lds
    buffer_load_dwordx4 v10, s[12:15], s66 offen offset:2048  lds
    buffer_load_dwordx4 v11, s[12:15], s66 offen offset:3072  lds
    s_add_u32 s66, s66, 131072
    s_and_b32 s66, s66, 0x1fffff
    s_waitcnt vmcnt(8)
    s_barrier
    s_add_u32 m0, s63, 131072
    s_nop 0
    buffer_load_dwordx4 v8, s[12:15], s66 offen offset:0  lds
    buffer_load_dwordx4 v9, s[12:15], s66 offen offset:1024  lds
    buffer_load_dwordx4 v10, s[12:15], s66 offen offset:2048  lds
    buffer_load_dwordx4 v11, s[12:15], s66 offen offset:3072  lds
    s_add_u32 s66, s66, 131072
    s_and_b32 s66, s66, 0x1fffff
    s_add_u32 m0, s64, 131072
    s_nop 0
    buffer_load_dwordx4 v12, s[8:11], s67 offen offset:0 sc1 lds
    buffer_load_dwordx4 v12, s[8:11], s67 offen offset:1024 sc1 lds
    buffer_load_dwordx4 v12, s[8:11], s67 offen offset:2048 sc1 lds
    buffer_load_dwordx4 v12, s[8:11], s67 offen offset:3072 sc1 lds
    s_add_u32 s67, s67, 4096
    s_and_b32 s67, s67, 65535
    s_add_u32 m0, s63, 0
    s_nop 0
    buffer_load_dwordx4 v8, s[12:15], s66 offen offset:0  lds
    buffer_load_dwordx4 v9, s[12:15], s66 offen offset:1024  lds
    buffer_load_dwordx4 v10, s[12:15], s66 offen offset:2048  lds
    buffer_load_dwordx4 v11, s[12:15], s66 offen offset:3072  lds
    s_add_u32 s66, s66, 131072
    s_and_b32 s66, s66, 0x1fffff
    s_add_u32 m0, s64, 0
    s_nop 0
    buffer_load_dwordx4 v12, s[8:11], s67 offen offset:0 sc1 lds
    buffer_load_dwordx4 v12, s[8:11], s67 offen offset:1024 sc1 lds
    buffer_load_dwordx4 v12, s[8:11], s67 offen offset:2048 sc1 lds
    buffer_load_dwordx4 v12, s[8:11], s67 offen offset:3072 sc1 lds
    s_add_u32 s67, s67, 4096
    s_and_b32 s67, s67, 65535
    s_waitcnt vmcnt(16)
    s_barrier
    s_add_u32 m0, s63, 32768
    s_nop 0
    buffer_load_dwordx4 v8, s[12:15], s66 offen offset:0  lds
    buffer_load_dwordx4 v9, s[12:15], s66 offen offset:1024  lds
    buffer_load_dwordx4 v10, s[12:15], s66 offen offset:2048  lds
    buffer_load_dwordx4 v11, s[12:15], s66 offen offset:3072  lds
    s_add_u32 s66, s66, 131072
    s_and_b32 s66, s66, 0x1fffff
    s_add_u32 m0, s64, 32768
    s_nop 0
    buffer_load_dwordx4 v12, s[8:11], s67 offen offset:0 sc1 lds
    buffer_load_dwordx4 v12, s[8:11], s67 offen offset:1024 sc1 lds
    buffer_load_dwordx4 v12, s[8:11], s67 offen offset:2048 sc1 lds
    buffer_load_dwordx4 v12, s[8:11], s67 offen offset:3072 sc1 lds
    s_add_u32 s67, s67, 4096
    s_and_b32 s67, s67, 65535
    s_waitcnt vmcnt(16)
    s_barrier
    s_add_u32 m0, s63, 65536
    s_nop 0
    buffer_load_dwordx4 v8, s[12:15], s66 offen offset:0  lds
    buffer_load_dwordx4 v9, s[12:15], s66 offen offset:1024  lds
    buffer_load_dwordx4 v10, s[12:15], s66 offen offset:2048  lds
    buffer_load_dwordx4 v11, s[12:15], s66 offen offset:3072  lds
    s_add_u32 s66, s66, 131072
    s_and_b32 s66, s66, 0x1fffff
    s_add_u32 m0, s64, 65536
    s_nop 0
    buffer_load_dwordx4 v12, s[8:11], s67 offen offset:0 sc1 lds
    buffer_load_dwordx4 v12, s[8:11], s67 offen offset:1024 sc1 lds
    buffer_load_dwordx4 v12, s[8:11], s67 offen offset:2048 sc1 lds
    buffer_load_dwordx4 v12, s[8:11], s67 offen offset:3072 sc1 lds
    s_add_u32 s67, s67, 4096
    s_and_b32 s67, s67, 65535
    s_waitcnt vmcnt(16)
    s_barrier
    s_add_u32 m0, s63, 98304
    s_nop 0
    buffer_load_dwordx4 v8, s[12:15], s66 offen offset:0  lds
    buffer_load_dwordx4 v9, s[12:15], s66 offen offset:1024  lds
    buffer_load_dwordx4 v10, s[12:15], s66 offen offset:2048  lds
    buffer_load_dwordx4 v11, s[12:15], s66 offen offset:3072  lds
    s_add_u32 s66, s66, 131072
    s_and_b32 s66, s66, 0x1fffff
    s_add_u32 m0, s64, 98304
    s_nop 0
    buffer_load_dwordx4 v12, s[8:11], s67 offen offset:0 sc1 lds
    buffer_load_dwordx4 v12, s[8:11], s67 offen offset:1024 sc1 lds
    buffer_load_dwordx4 v12, s[8:11], s67 offen offset:2048 sc1 lds
    buffer_load_dwordx4 v12, s[8:11], s67 offen offset:3072 sc1 lds
    s_add_u32 s67, s67, 4096
    s_and_b32 s67, s67, 65535
    s_waitcnt vmcnt(16)
    s_barrier
    s_add_u32 m0, s63, 131072
    s_nop 0
    buffer_load_dwordx4 v8, s[12:15], s66 offen offset:0  lds
    buffer_load_dwordx4 v9, s[12:15], s66 offen offset:1024  lds
    buffer_load_dwordx4 v10, s[12:15], s66 offen offset:2048  lds
    buffer_load_dwordx4 v11, s[12:15], s66 offen offset:3072  lds
    s_add_u32 s66, s66, 131072
    s_and_b32 s66, s66, 0x1fffff
    s_add_u32 m0, s64, 131072
    s_nop 0
    buffer_load_dwordx4 v12, s[8:11], s67 offen offset:0 sc1 lds
    buffer_load_dwordx4 v12, s[8:11], s67 offen offset:1024 sc1 lds
    buffer_load_dwordx4 v12, s[8:11], s67 offen offset:2048 sc1 lds
    buffer_load_dwordx4 v12, s[8:11], s67 offen offset:3072 sc1 lds
    s_add_u32 s67, s67, 4096
    s_and_b32 s67, s67, 65535
    s_waitcnt vmcnt(16)
    s_barrier
    s_add_u32 m0, s63, 0
    s_nop 0
    buffer_load_dwordx4 v8, s[12:15], s66 offen offset:0  lds
    buffer_load_dwordx4 v9, s[12:15], s66 offen offset:1024  lds
    buffer_load_dwordx4 v10, s[12:15], s66 offen offset:2048  lds
    buffer_load_dwordx4 v11, s[12:15], s66 offen offset:3072  lds
    s_add_u32 s66, s66, 131072
    s_and_b32 s66, s66, 0x1fffff
    s_add_u32 m0, s64, 0
    s_nop 0
    buffer_load_dwordx4 v12, s[8:11], s67 offen offset:0 sc1 lds
    buffer_load_dwordx4 v12, s[8:11], s67 offen offset:1024 sc1 lds
    buffer_load_dwordx4 v12, s[8:11], s67 offen offset:2048 sc1 lds
    buffer_load_dwordx4 v12, s[8:11], s67 offen offset:3072 sc1 lds
    s_add_u32 s67, s67, 4096
    s_and_b32 s67, s67, 65535
    s_waitcnt vmcnt(16)
    s_barrier
    s_add_u32 m0, s63, 32768
    s_nop 0
    buffer_load_dwordx4 v8, s[12:15], s66 offen offset:0  lds
    buffer_load_dwordx4 v9, s[12:15], s66 offen offset:1024  lds
    buffer_load_dwordx4 v10, s[12:15], s66 offen offset:2048  lds
    buffer_load_dwordx4 v11, s[12:15], s66 offen offset:3072  lds
    s_add_u32 s66, s66, 131072
    s_and_b32 s66, s66, 0x1fffff
    s_add_u32 m0, s64, 32768
    s_nop 0
    buffer_load_dwordx4 v12, s[8:11], s67 offen offset:0 sc1 lds
    buffer_load_dwordx4 v12, s[8:11], s67 offen offset:1024 sc1 lds
    buffer_load_dwordx4 v12, s[8:11], s67 offen offset:2048 sc1 lds
    buffer_load_dwordx4 v12, s[8:11], s67 offen offset:3072 sc1 lds
    s_add_u32 s67, s67, 4096
    s_and_b32 s67, s67, 65535
    s_waitcnt vmcnt(16)
    s_barrier
    s_add_u32 m0, s63, 65536
    s_nop 0
    buffer_load_dwordx4 v8, s[12:15], s66 offen offset:0  lds
    buffer_load_dwordx4 v9, s[12:15], s66 offen offset:1024  lds
    buffer_load_dwordx4 v10, s[12:15], s66 offen offset:2048  lds
    buffer_load_dwordx4 v11, s[12:15], s66 offen offset:3072  lds
    s_add_u32 s66, s66, 131072
    s_and_b32 s66, s66, 0x1fffff
    s_add_u32 m0, s64, 65536
    s_nop 0
    buffer_load_dwordx4 v12, s[8:11], s67 offen offset:0 sc1 lds
    buffer_load_dwordx4 v12, s[8:11], s67 offen offset:1024 sc1 lds
    buffer_load_dwordx4 v12, s[8:11], s67 offen offset:2048 sc1 lds
    buffer_load_dwordx4 v12, s[8:11], s67 offen offset:3072 sc1 lds
    s_add_u32 s67, s67, 4096
    s_and_b32 s67, s67, 65535
    s_waitcnt vmcnt(16)
    s_barrier
    s_add_u32 m0, s63, 98304
    s_nop 0
    buffer_load_dwordx4 v8, s[12:15], s66 offen offset:0  lds
    buffer_load_dwordx4 v9, s[12:15], s66 offen offset:1024  lds
    buffer_load_dwordx4 v10, s[12:15], s66 offen offset:2048  lds
    buffer_load_dwordx4 v11, s[12:15], s66 offen offset:3072  lds
    s_add_u32 s66, s66, 131072
    s_and_b32 s66, s66, 0x1fffff
    s_add_u32 m0, s64, 98304
    s_nop 0
    buffer_load_dwordx4 v12, s[8:11], s67 offen offset:0 sc1 lds
    buffer_load_dwordx4 v12, s[8:11], s67 offen offset:1024 sc1 lds
    buffer_load_dwordx4 v12, s[8:11], s67 offen offset:2048 sc1 lds
    buffer_load_dwordx4 v12, s[8:11], s67 offen offset:3072 sc1 lds
    s_add_u32 s67, s67, 4096
    s_and_b32 s67, s67, 65535
    s_waitcnt vmcnt(16)
    s_barrier
    s_add_u32 m0, s63, 131072
    s_nop 0
    buffer_load_dwordx4 v8, s[12:15], s66 offen offset:0  lds
    buffer_load_dwordx4 v9, s[12:15], s66 offen offset:1024  lds
    buffer_load_dwordx4 v10, s[12:15], s66 offen offset:2048  lds
    buffer_load_dwordx4 v11, s[12:15], s66 offen offset:3072  lds
    s_add_u32 s66, s66, 131072
    s_and_b32 s66, s66, 0x1fffff
    s_add_u32 m0, s64, 131072
    s_nop 0
    buffer_load_dwordx4 v12, s[8:11], s67 offen offset:0 sc1 lds
    buffer_load_dwordx4 v12, s[8:11], s67 offen offset:1024 sc1 lds
    buffer_load_dwordx4 v12, s[8:11], s67 offen offset:2048 sc1 lds
    buffer_load_dwordx4 v12, s[8:11], s67 offen offset:3072 sc1 lds
    s_add_u32 s67, s67, 4096
    s_and_b32 s67, s67, 65535
    s_waitcnt vmcnt(16)
    s_barrier
    s_waitcnt vmcnt(8)
    s_barrier
    s_waitcnt vmcnt(0)
    s_barrier
    s_endpgm
L_compute:
    v_and_b32 v152, 6, v2
    v_mov_b32 v153, 0x3f803f80
    v_cmp_eq_u32 vcc, 0, v152
    s_nop 1
    v_cndmask_b32 v8, 0, v153, vcc
    v_cndmask_b32 v9, 0, v153, vcc
    v_cmp_eq_u32 vcc, 4, v152
    s_nop 1
    v_cndmask_b32 v10, 0, v153, vcc
    v_cndmask_b32 v11, 0, v153, vcc
    v_and_b32 v152, 1, v2
    v_mov_b32 v153, 0x4444
    v_mov_b32 v154, 0xeeee
    v_cmp_eq_u32 vcc, 0, v152
    s_nop 1
    v_cndmask_b32 v12, v154, v153, vcc
    s_lshl_b32 s61, s3, 22
    s_add_u32 s61, s61, 1048576
    s_lshl_b32 s60, s4, 2
    s_and_b32 s62, s6, 3
    s_add_u32 s60, s60, s62
    s_lshl_b32 s60, s60, 16
    s_add_u32 s61, s61, s60
    s_lshl_b32 s60, s5, 2
    s_lshr_b32 s62, s6, 2
    s_lshl_b32 s62, s62, 1
    s_add_u32 s60, s60, s62
    s_lshl_b32 s60, s60, 11
    s_add_u32 s61, s61, s60
    v_mov_b32 v144, 0
    v_mov_b32 v145, 0
    v_mov_b32 v146, 0
    v_mov_b32 v147, 0
    v_mov_b32 v148, 0
    v_mov_b32 v149, 0
    v_mov_b32 v150, 0
    v_mov_b32 v151, 0
    v_and_b32 v20, 31, v2
    v_lshrrev_b32 v21, 5, v2
    v_and_b32 v22, 15, v2
    s_lshl_b32 s60, s6, 13
    s_add_u32 s60, s60, 32768
    v_lshlrev_b32 v20, 8, v20
    v_add_u32 v20, s60, v20
    v_or_b32 v23, 0, v21
    v_xor_b32 v23, v23, v22
    v_lshl_add_u32 v24, v23, 4, v20
    v_or_b32 v23, 2, v21
    v_xor_b32 v23, v23, v22
    v_lshl_add_u32 v25, v23, 4, v20
    v_or_b32 v23, 4, v21
    v_xor_b32 v23, v23, v22
    v_lshl_add_u32 v26, v23, 4, v20
    v_or_b32 v23, 6, v21
    v_xor_b32 v23, v23, v22
    v_lshl_add_u32 v27, v23, 4, v20
    v_or_b32 v23, 8, v21
    v_xor_b32 v23, v23, v22
    v_lshl_add_u32 v28, v23, 4, v20
    v_or_b32 v23, 10, v21
    v_xor_b32 v23, v23, v22
    v_lshl_add_u32 v29, v23, 4, v20
    v_or_b32 v23, 12, v21
    v_xor_b32 v23, v23, v22
    v_lshl_add_u32 v30, v23, 4, v20
    v_or_b32 v23, 14, v21
    v_xor_b32 v23, v23, v22
    v_lshl_add_u32 v31, v23, 4, v20
    s_lshl_b32 s60, s6, 13
    s_add_u32 s62, s60, 98304
    v_bfe_u32 v16, v2, 2, 2
    v_lshl_add_u32 v16, v21, 3, v16
    v_lshlrev_b32 v16, 6, v16
    v_bfe_u32 v17, v2, 4, 1
    v_lshl_add_u32 v16, v17, 5, v16
    v_and_b32 v17, 3, v2
    v_lshl_add_u32 v16, v17, 3, v16
    v_add_u32 v16, s62, v16
    v_mov_b32 v64, 0
    v_mov_b32 v65, 0
    v_mov_b32 v66, 0
    v_mov_b32 v67, 0
    v_mov_b32 v68, 0
    v_mov_b32 v69, 0
    v_mov_b32 v70, 0
    v_mov_b32 v71, 0
    v_mov_b32 v72, 0
    v_mov_b32 v73, 0
    v_mov_b32 v74, 0
    v_mov_b32 v75, 0
    v_mov_b32 v76, 0
    v_mov_b32 v77, 0
    v_mov_b32 v78, 0
    v_mov_b32 v79, 0
    v_bfe_u32 v124, v2, 2, 2
    v_lshrrev_b32 v125, 4, v2
    v_lshl_add_u32 v126, v125, 3, v124
    v_lshlrev_b32 v126, 8, v126
    v_and_b32 v127, 3, v2
    v_lshl_add_u32 v126, v127, 3, v126
    v_lshlrev_b32 v124, 1, v124
    v_and_b32 v125, 1, v125
    v_xor_b32 v124, v124, v125
    s_lshr_b32 s70, s6, 2
    s_lshl_b32 s70, s70, 2
    v_xor_b32 v124, s70, v124
    v_xor_b32 v125, 0, v124
    v_lshl_add_u32 v128, v125, 5, v126
    v_xor_b32 v125, 1, v124
    v_lshl_add_u32 v129, v125, 5, v126
    v_xor_b32 v125, 2, v124
    v_lshl_add_u32 v130, v125, 5, v126
    v_xor_b32 v125, 3, v124
    v_lshl_add_u32 v131, v125, 5, v126
    s_and_b32 s70, s6, 3
    s_lshl_b32 s70, s70, 5
    v_and_b32 v124, 15, v2
    v_add_u32 v124, s70, v124
    v_bfe_u32 v125, v124, 1, 3
    v_lshrrev_b32 v126, 4, v2
    v_xor_b32 v125, v125, v126
    v_lshlrev_b32 v124, 7, v124
    v_add_u32 v124, 16384, v124
    v_lshl_add_u32 v132, v125, 4, v124
    v_xor_b32 v133, 64, v132
    s_mov_b32 s75, 0
    v_lshlrev_b32 v18, 4, v2
    s_lshl_b32 s60, s6, 12
    s_add_u32 s60, s60, 131072
    v_add_u32 v19, s60, v18
    s_barrier
    ds_read_b128 v[32:35], v24
    ds_read_b64_tr_b16 v[80:81], v16 offset:0
    ds_read_b64_tr_b16 v[82:83], v16 offset:256
    ds_read_b128 v[36:39], v25
    ds_read_b64_tr_b16 v[84:85], v16 offset:1024
    ds_read_b64_tr_b16 v[86:87], v16 offset:1280
    s_waitcnt lgkmcnt(6)
    ds_read_b128 v[40:43], v26
    ds_read_b64_tr_b16 v[88:89], v16 offset:2048
    ds_read_b64_tr_b16 v[90:91], v16 offset:2304
    ds_read_b128 v[44:47], v27
    ds_read_b64_tr_b16 v[92:93], v16 offset:3072
    ds_read_b64_tr_b16 v[94:95], v16 offset:3328
    s_waitcnt lgkmcnt(6)
    ds_read_b128 v[48:51], v28
    ds_read_b64_tr_b16 v[96:97], v16 offset:4096
    ds_read_b64_tr_b16 v[98:99], v16 offset:4352
    ds_read_b128 v[52:55], v29
    ds_read_b64_tr_b16 v[100:101], v16 offset:5120
    ds_read_b64_tr_b16 v[102:103], v16 offset:5376
    s_waitcnt lgkmcnt(6)
    ds_read_b128 v[56:59], v30
    ds_read_b64_tr_b16 v[104:105], v16 offset:6144
    ds_read_b64_tr_b16 v[106:107], v16 offset:6400
    ds_read_b128 v[60:63], v31
    ds_read_b64_tr_b16 v[108:109], v16 offset:7168
    ds_read_b64_tr_b16 v[110:111], v16 offset:7424
    s_and_b32 s60, s5, 1
    s_cmp_eq_u32 s60, 0
    s_waitcnt lgkmcnt(0)
    s_barrier
    s_cbranch_scc0 L_kv_isv
    v_mfma_f32_32x32x16_bf16 v[64:79], v[80:83], v[32:35], v[64:79]
    v_mfma_f32_32x32x16_bf16 v[64:79], v[84:87], v[36:39], v[64:79]
    v_mfma_f32_32x32x16_bf16 v[64:79], v[88:91], v[40:43], v[64:79]
    v_mfma_f32_32x32x16_bf16 v[64:79], v[92:95], v[44:47], v[64:79]
    v_mfma_f32_32x32x16_bf16 v[64:79], v[96:99], v[48:51], v[64:79]
    v_mfma_f32_32x32x16_bf16 v[64:79], v[100:103], v[52:55], v[64:79]
    v_mfma_f32_32x32x16_bf16 v[64:79], v[104:107], v[56:59], v[64:79]
    v_mfma_f32_32x32x16_bf16 v[64:79], v[108:111], v[60:63], v[64:79]
    s_branch L_kv_red
L_kv_isv:
    v_mfma_f32_32x32x16_bf16 v[64:79], v[32:35], v[80:83], v[64:79]
    v_mfma_f32_32x32x16_bf16 v[64:79], v[36:39], v[84:87], v[64:79]
    v_mfma_f32_32x32x16_bf16 v[64:79], v[40:43], v[88:91], v[64:79]
    v_mfma_f32_32x32x16_bf16 v[64:79], v[44:47], v[92:95], v[64:79]
    v_mfma_f32_32x32x16_bf16 v[64:79], v[48:51], v[96:99], v[64:79]
    v_mfma_f32_32x32x16_bf16 v[64:79], v[52:55], v[100:103], v[64:79]
    v_mfma_f32_32x32x16_bf16 v[64:79], v[56:59], v[104:107], v[64:79]
    v_mfma_f32_32x32x16_bf16 v[64:79], v[60:63], v[108:111], v[64:79]
L_kv_red:
    s_nop 15
    ds_write_b128 v19, v[64:67] offset:0
    ds_write_b128 v19, v[68:71] offset:1024
    ds_write_b128 v19, v[72:75] offset:2048
    ds_write_b128 v19, v[76:79] offset:3072
    s_waitcnt lgkmcnt(0)
    s_barrier
    v_mov_b32 v64, 0
    v_mov_b32 v65, 0
    v_mov_b32 v66, 0
    v_mov_b32 v67, 0
    v_mov_b32 v68, 0
    v_mov_b32 v69, 0
    v_mov_b32 v70, 0
    v_mov_b32 v71, 0
    v_mov_b32 v32, 0
    v_mov_b32 v33, 0
    v_mov_b32 v34, 0
    v_mov_b32 v35, 0
    v_mov_b32 v36, 0
    v_mov_b32 v37, 0
    v_mov_b32 v38, 0
    v_mov_b32 v39, 0
    v_mov_b32 v40, 0
    v_mov_b32 v41, 0
    v_mov_b32 v42, 0
    v_mov_b32 v43, 0
    v_mov_b32 v44, 0
    v_mov_b32 v45, 0
    v_mov_b32 v46, 0
    v_mov_b32 v47, 0
    v_mov_b32 v48, 0
    v_mov_b32 v49, 0
    v_mov_b32 v50, 0
    v_mov_b32 v51, 0
    v_mov_b32 v52, 0
    v_mov_b32 v53, 0
    v_mov_b32 v54, 0
    v_mov_b32 v55, 0
    v_mov_b32 v56, 0
    v_mov_b32 v57, 0
    v_mov_b32 v58, 0
    v_mov_b32 v59, 0
    v_mov_b32 v60, 0
    v_mov_b32 v61, 0
    v_mov_b32 v62, 0
    v_mov_b32 v63, 0
    s_barrier
    ds_read_b128 v[104:107], v132 offset:0
    ds_read_b128 v[108:111], v132 offset:2048
    ds_read_b64_tr_b16 v[72:73], v128 offset:0
    ds_read_b64_tr_b16 v[74:75], v129 offset:1024
    ds_read_b64_tr_b16 v[76:77], v129 offset:0
    ds_read_b64_tr_b16 v[78:79], v128 offset:1024
    ds_read_b64_tr_b16 v[80:81], v130 offset:0
    ds_read_b64_tr_b16 v[82:83], v131 offset:1024
    ds_read_b64_tr_b16 v[84:85], v131 offset:0
    ds_read_b64_tr_b16 v[86:87], v130 offset:1024
    s_mov_b32 s69, 15
.p2align 6
L_q_loop:
    s_barrier
    s_setprio 3
    s_waitcnt lgkmcnt(0)
    v_mfma_f32_16x16x32_bf16 v[32:35], v[72:75], v[104:107], v[32:35]
    ds_read_b128 v[112:115], v133 offset:0
    ds_read_b128 v[116:119], v133 offset:2048
    v_mfma_f32_16x16x32_bf16 v[36:39], v[72:75], v[108:111], v[36:39]
    ds_read_b64_tr_b16 v[88:89], v128 offset:8192
    v_mfma_f32_16x16x32_bf16 v[40:43], v[76:79], v[104:107], v[40:43]
    ds_read_b64_tr_b16 v[90:91], v129 offset:9216
    ds_read_b64_tr_b16 v[92:93], v129 offset:8192
    v_mfma_f32_16x16x32_bf16 v[44:47], v[76:79], v[108:111], v[44:47]
    ds_read_b64_tr_b16 v[94:95], v128 offset:9216
    v_mfma_f32_16x16x32_bf16 v[48:51], v[80:83], v[104:107], v[48:51]
    ds_read_b64_tr_b16 v[96:97], v130 offset:8192
    v_mfma_f32_16x16x32_bf16 v[52:55], v[80:83], v[108:111], v[52:55]
    ds_read_b64_tr_b16 v[98:99], v131 offset:9216
    v_mfma_f32_16x16x32_bf16 v[56:59], v[84:87], v[104:107], v[56:59]
    ds_read_b64_tr_b16 v[100:101], v131 offset:8192
    v_mfma_f32_16x16x32_bf16 v[60:63], v[84:87], v[108:111], v[60:63]
    ds_read_b64_tr_b16 v[102:103], v130 offset:9216
    s_add_u32 s70, s75, 32768
    s_cmp_eq_u32 s70, 163840
    s_cselect_b32 s70, 0, s70
    s_sub_u32 s76, s70, s75
    s_mov_b32 s75, s70
    v_add_u32 v128, s76, v128
    v_add_u32 v129, s76, v129
    v_add_u32 v130, s76, v130
    v_add_u32 v131, s76, v131
    v_add_u32 v132, s76, v132
    v_add_u32 v133, s76, v133
    s_setprio 1
    s_waitcnt lgkmcnt(0)
    v_mfma_f32_16x16x32_bf16 v[32:35], v[88:91], v[112:115], v[32:35]
    ds_read_b128 v[104:107], v132 offset:0
    ds_read_b128 v[108:111], v132 offset:2048
    v_mfma_f32_16x16x32_bf16 v[36:39], v[88:91], v[116:119], v[36:39]
    ds_read_b64_tr_b16 v[72:73], v128 offset:0
    v_mfma_f32_16x16x32_bf16 v[40:43], v[92:95], v[112:115], v[40:43]
    ds_read_b64_tr_b16 v[74:75], v129 offset:1024
    ds_read_b64_tr_b16 v[76:77], v129 offset:0
    v_mfma_f32_16x16x32_bf16 v[44:47], v[92:95], v[116:119], v[44:47]
    ds_read_b64_tr_b16 v[78:79], v128 offset:1024
    v_mfma_f32_16x16x32_bf16 v[48:51], v[96:99], v[112:115], v[48:51]
    ds_read_b64_tr_b16 v[80:81], v130 offset:0
    v_mfma_f32_16x16x32_bf16 v[52:55], v[96:99], v[116:119], v[52:55]
    ds_read_b64_tr_b16 v[82:83], v131 offset:1024
    v_mfma_f32_16x16x32_bf16 v[56:59], v[100:103], v[112:115], v[56:59]
    ds_read_b64_tr_b16 v[84:85], v131 offset:0
    v_mfma_f32_16x16x32_bf16 v[60:63], v[100:103], v[116:119], v[60:63]
    ds_read_b64_tr_b16 v[86:87], v130 offset:1024
    s_sub_u32 s69, s69, 1
    s_cmp_lg_u32 s69, 0
    s_cbranch_scc1 L_q_loop
    s_setprio 3
    s_waitcnt lgkmcnt(0)
    v_mfma_f32_16x16x32_bf16 v[32:35], v[72:75], v[104:107], v[32:35]
    ds_read_b128 v[112:115], v133 offset:0
    ds_read_b128 v[116:119], v133 offset:2048
    v_mfma_f32_16x16x32_bf16 v[36:39], v[72:75], v[108:111], v[36:39]
    ds_read_b64_tr_b16 v[88:89], v128 offset:8192
    v_mfma_f32_16x16x32_bf16 v[40:43], v[76:79], v[104:107], v[40:43]
    ds_read_b64_tr_b16 v[90:91], v129 offset:9216
    ds_read_b64_tr_b16 v[92:93], v129 offset:8192
    v_mfma_f32_16x16x32_bf16 v[44:47], v[76:79], v[108:111], v[44:47]
    ds_read_b64_tr_b16 v[94:95], v128 offset:9216
    v_mfma_f32_16x16x32_bf16 v[48:51], v[80:83], v[104:107], v[48:51]
    ds_read_b64_tr_b16 v[96:97], v130 offset:8192
    v_mfma_f32_16x16x32_bf16 v[52:55], v[80:83], v[108:111], v[52:55]
    ds_read_b64_tr_b16 v[98:99], v131 offset:9216
    v_mfma_f32_16x16x32_bf16 v[56:59], v[84:87], v[104:107], v[56:59]
    ds_read_b64_tr_b16 v[100:101], v131 offset:8192
    v_mfma_f32_16x16x32_bf16 v[60:63], v[84:87], v[108:111], v[60:63]
    ds_read_b64_tr_b16 v[102:103], v130 offset:9216
    s_setprio 1
    s_waitcnt lgkmcnt(0)
    v_mfma_f32_16x16x32_bf16 v[32:35], v[88:91], v[112:115], v[32:35]
    v_mfma_f32_16x16x32_bf16 v[36:39], v[88:91], v[116:119], v[36:39]
    v_mfma_f32_16x16x32_bf16 v[40:43], v[92:95], v[112:115], v[40:43]
    v_mfma_f32_16x16x32_bf16 v[44:47], v[92:95], v[116:119], v[44:47]
    v_mfma_f32_16x16x32_bf16 v[48:51], v[96:99], v[112:115], v[48:51]
    v_mfma_f32_16x16x32_bf16 v[52:55], v[96:99], v[116:119], v[52:55]
    v_mfma_f32_16x16x32_bf16 v[56:59], v[100:103], v[112:115], v[56:59]
    v_mfma_f32_16x16x32_bf16 v[60:63], v[100:103], v[116:119], v[60:63]
    s_setprio 0
    s_nop 7
    v_cvt_pk_bf16_f32 v16, v32, v33
    v_cvt_pk_bf16_f32 v17, v34, v35
    v_cvt_pk_bf16_f32 v18, v36, v37
    v_cvt_pk_bf16_f32 v19, v38, v39
    v_cvt_pk_bf16_f32 v20, v40, v41
    v_cvt_pk_bf16_f32 v21, v42, v43
    v_cvt_pk_bf16_f32 v22, v44, v45
    v_cvt_pk_bf16_f32 v23, v46, v47
    v_cvt_pk_bf16_f32 v24, v48, v49
    v_cvt_pk_bf16_f32 v25, v50, v51
    v_cvt_pk_bf16_f32 v26, v52, v53
    v_cvt_pk_bf16_f32 v27, v54, v55
    v_cvt_pk_bf16_f32 v28, v56, v57
    v_cvt_pk_bf16_f32 v29, v58, v59
    v_cvt_pk_bf16_f32 v30, v60, v61
    v_cvt_pk_bf16_f32 v31, v62, v63
    s_nop 1
    v_permlane16_swap_b32 v16, v18
    v_permlane16_swap_b32 v17, v19
    v_permlane16_swap_b32 v20, v22
    v_permlane16_swap_b32 v21, v23
    v_permlane16_swap_b32 v24, v26
    v_permlane16_swap_b32 v25, v27
    v_permlane16_swap_b32 v28, v30
    v_permlane16_swap_b32 v29, v31
    s_barrier
    v_lshlrev_b32 v1, 4, v2
    v_add_u32 v1, 32768, v1
    ds_read_b128 v[120:123], v1 offset:0
    ds_read_b128 v[124:127], v1 offset:1024
    ds_read_b128 v[136:139], v1 offset:2048
    ds_read_b128 v[140:143], v1 offset:3072
    v_mov_b32 v32, 0
    v_mov_b32 v33, 0
    v_mov_b32 v34, 0
    v_mov_b32 v35, 0
    v_mov_b32 v36, 0
    v_mov_b32 v37, 0
    v_mov_b32 v38, 0
    v_mov_b32 v39, 0
    v_mov_b32 v40, 0
    v_mov_b32 v41, 0
    v_mov_b32 v42, 0
    v_mov_b32 v43, 0
    v_mov_b32 v44, 0
    v_mov_b32 v45, 0
    v_mov_b32 v46, 0
    v_mov_b32 v47, 0
    v_mov_b32 v48, 0
    v_mov_b32 v49, 0
    v_mov_b32 v50, 0
    v_mov_b32 v51, 0
    v_mov_b32 v52, 0
    v_mov_b32 v53, 0
    v_mov_b32 v54, 0
    v_mov_b32 v55, 0
    v_mov_b32 v56, 0
    v_mov_b32 v57, 0
    v_mov_b32 v58, 0
    v_mov_b32 v59, 0
    v_mov_b32 v60, 0
    v_mov_b32 v61, 0
    v_mov_b32 v62, 0
    v_mov_b32 v63, 0
    v_mov_b32 v112, 0
    v_mov_b32 v113, 0
    v_mov_b32 v114, 0
    v_mov_b32 v115, 0
    v_mov_b32 v116, 0
    v_mov_b32 v117, 0
    v_mov_b32 v118, 0
    v_mov_b32 v119, 0
    s_waitcnt lgkmcnt(0)
    v_mfma_f32_32x32x16_bf16 v[72:87], v[120:123], v[16:19], 0
    v_mfma_f32_32x32x16_bf16 v[72:87], v[124:127], v[20:23], v[72:87]
    s_mov_b32 s75, 32768
    s_mov_b32 s76, 65536
    s_mov_b32 s77, 98304
    s_mov_b32 s69, 0
    s_nop 7
    s_branch L_att_entry
.p2align 6
L_att_loop:
    s_waitcnt lgkmcnt(0)
    s_barrier
    s_mov_b32 s60, s75
    s_mov_b32 s75, s76
    s_mov_b32 s76, s77
    s_mov_b32 s77, s60
    v_lshlrev_b32 v1, 4, v2
    v_add_u32 v1, s75, v1
    s_setprio 3
    v_mfma_f32_32x32x16_bf16 v[88:103], v[128:131], v[24:27], 0
    ds_read_b128 v[120:123], v1 offset:0
    v_exp_f32 v72, v72
    v_exp_f32 v73, v73
    v_exp_f32 v74, v74
    v_exp_f32 v75, v75
    v_mfma_f32_32x32x16_bf16 v[88:103], v[132:135], v[28:31], v[88:103]
    ds_read_b128 v[124:127], v1 offset:1024
    v_exp_f32 v76, v76
    v_exp_f32 v77, v77
    v_exp_f32 v78, v78
    v_cvt_pk_bf16_f32 v104, v72, v73
    v_cvt_pk_bf16_f32 v105, v74, v75
    v_mfma_f32_32x32x16_bf16 v[48:63], v[136:139], v[112:115], v[48:63]
    v_exp_f32 v79, v79
    v_exp_f32 v80, v80
    v_exp_f32 v81, v81
    v_cvt_pk_bf16_f32 v106, v76, v77
    v_cvt_pk_bf16_f32 v107, v78, v79
    v_mfma_f32_32x32x16_bf16 v[48:63], v[140:143], v[116:119], v[48:63]
    v_exp_f32 v82, v82
    v_exp_f32 v83, v83
    v_exp_f32 v84, v84
    v_cvt_pk_bf16_f32 v108, v80, v81
    v_cvt_pk_bf16_f32 v109, v82, v83
    v_smfmac_f32_16x16x64_bf16 v[68:71], v[8:11], v[112:119], v12
    v_exp_f32 v85, v85
    v_exp_f32 v86, v86
    v_exp_f32 v87, v87
    v_cvt_pk_bf16_f32 v110, v84, v85
    v_cvt_pk_bf16_f32 v111, v86, v87
    s_waitcnt lgkmcnt(0)
    v_mfma_f32_32x32x16_bf16 v[72:87], v[120:123], v[16:19], 0
    ds_read_b128 v[136:139], v1 offset:2048
    v_exp_f32 v88, v88
    v_exp_f32 v89, v89
    v_exp_f32 v90, v90
    v_exp_f32 v91, v91
    v_mfma_f32_32x32x16_bf16 v[72:87], v[124:127], v[20:23], v[72:87]
    ds_read_b128 v[140:143], v1 offset:3072
    v_exp_f32 v92, v92
    v_exp_f32 v93, v93
    v_exp_f32 v94, v94
    v_cvt_pk_bf16_f32 v112, v88, v89
    v_cvt_pk_bf16_f32 v113, v90, v91
    v_mfma_f32_32x32x16_bf16 v[32:47], v[144:147], v[104:107], v[32:47]
    v_exp_f32 v95, v95
    v_exp_f32 v96, v96
    v_exp_f32 v97, v97
    v_cvt_pk_bf16_f32 v114, v92, v93
    v_cvt_pk_bf16_f32 v115, v94, v95
    v_mfma_f32_32x32x16_bf16 v[32:47], v[148:151], v[108:111], v[32:47]
    v_exp_f32 v98, v98
    v_exp_f32 v99, v99
    v_exp_f32 v100, v100
    v_cvt_pk_bf16_f32 v116, v96, v97
    v_cvt_pk_bf16_f32 v117, v98, v99
    v_smfmac_f32_16x16x64_bf16 v[64:67], v[8:11], v[104:111], v12
    v_exp_f32 v101, v101
    v_exp_f32 v102, v102
    v_exp_f32 v103, v103
    v_cvt_pk_bf16_f32 v118, v100, v101
    v_cvt_pk_bf16_f32 v119, v102, v103
L_att_entry:
    v_mfma_f32_32x32x16_bf16 v[88:103], v[120:123], v[24:27], 0
    ds_read_b128 v[128:131], v1 offset:4096
    v_exp_f32 v72, v72
    v_exp_f32 v73, v73
    v_exp_f32 v74, v74
    v_exp_f32 v75, v75
    v_mfma_f32_32x32x16_bf16 v[88:103], v[124:127], v[28:31], v[88:103]
    ds_read_b128 v[132:135], v1 offset:5120
    v_exp_f32 v76, v76
    v_exp_f32 v77, v77
    v_exp_f32 v78, v78
    v_cvt_pk_bf16_f32 v104, v72, v73
    v_cvt_pk_bf16_f32 v105, v74, v75
    v_mfma_f32_32x32x16_bf16 v[48:63], v[144:147], v[112:115], v[48:63]
    v_exp_f32 v79, v79
    v_exp_f32 v80, v80
    v_exp_f32 v81, v81
    v_cvt_pk_bf16_f32 v106, v76, v77
    v_cvt_pk_bf16_f32 v107, v78, v79
    v_mfma_f32_32x32x16_bf16 v[48:63], v[148:151], v[116:119], v[48:63]
    v_exp_f32 v82, v82
    v_exp_f32 v83, v83
    v_exp_f32 v84, v84
    v_cvt_pk_bf16_f32 v108, v80, v81
    v_cvt_pk_bf16_f32 v109, v82, v83
    v_smfmac_f32_16x16x64_bf16 v[68:71], v[8:11], v[112:119], v12
    v_exp_f32 v85, v85
    v_exp_f32 v86, v86
    v_exp_f32 v87, v87
    v_cvt_pk_bf16_f32 v110, v84, v85
    v_cvt_pk_bf16_f32 v111, v86, v87
    s_waitcnt lgkmcnt(0)
    v_mfma_f32_32x32x16_bf16 v[72:87], v[128:131], v[16:19], 0
    ds_read_b128 v[144:147], v1 offset:6144
    v_exp_f32 v88, v88
    v_exp_f32 v89, v89
    v_exp_f32 v90, v90
    v_exp_f32 v91, v91
    v_mfma_f32_32x32x16_bf16 v[72:87], v[132:135], v[20:23], v[72:87]
    ds_read_b128 v[148:151], v1 offset:7168
    v_exp_f32 v92, v92
    v_exp_f32 v93, v93
    v_exp_f32 v94, v94
    v_cvt_pk_bf16_f32 v112, v88, v89
    v_cvt_pk_bf16_f32 v113, v90, v91
    v_mfma_f32_32x32x16_bf16 v[32:47], v[136:139], v[104:107], v[32:47]
    v_exp_f32 v95, v95
    v_exp_f32 v96, v96
    v_exp_f32 v97, v97
    v_cvt_pk_bf16_f32 v114, v92, v93
    v_cvt_pk_bf16_f32 v115, v94, v95
    v_mfma_f32_32x32x16_bf16 v[32:47], v[140:143], v[108:111], v[32:47]
    v_exp_f32 v98, v98
    v_exp_f32 v99, v99
    v_exp_f32 v100, v100
    v_cvt_pk_bf16_f32 v116, v96, v97
    v_cvt_pk_bf16_f32 v117, v98, v99
    v_smfmac_f32_16x16x64_bf16 v[64:67], v[8:11], v[104:111], v12
    v_exp_f32 v101, v101
    v_exp_f32 v102, v102
    v_exp_f32 v103, v103
    v_cvt_pk_bf16_f32 v118, v100, v101
    v_cvt_pk_bf16_f32 v119, v102, v103
    s_setprio 2
    v_mfma_f32_32x32x16_bf16 v[88:103], v[128:131], v[24:27], 0
    ds_read_b128 v[120:123], v1 offset:8192
    v_exp_f32 v72, v72
    v_exp_f32 v73, v73
    v_exp_f32 v74, v74
    v_exp_f32 v75, v75
    v_mfma_f32_32x32x16_bf16 v[88:103], v[132:135], v[28:31], v[88:103]
    ds_read_b128 v[124:127], v1 offset:9216
    v_exp_f32 v76, v76
    v_exp_f32 v77, v77
    v_exp_f32 v78, v78
    v_cvt_pk_bf16_f32 v104, v72, v73
    v_cvt_pk_bf16_f32 v105, v74, v75
    v_mfma_f32_32x32x16_bf16 v[48:63], v[136:139], v[112:115], v[48:63]
    v_exp_f32 v79, v79
    v_exp_f32 v80, v80
    v_exp_f32 v81, v81
    v_cvt_pk_bf16_f32 v106, v76, v77
    v_cvt_pk_bf16_f32 v107, v78, v79
    v_mfma_f32_32x32x16_bf16 v[48:63], v[140:143], v[116:119], v[48:63]
    v_exp_f32 v82, v82
    v_exp_f32 v83, v83
    v_exp_f32 v84, v84
    v_cvt_pk_bf16_f32 v108, v80, v81
    v_cvt_pk_bf16_f32 v109, v82, v83
    v_smfmac_f32_16x16x64_bf16 v[68:71], v[8:11], v[112:119], v12
    v_exp_f32 v85, v85
    v_exp_f32 v86, v86
    v_exp_f32 v87, v87
    v_cvt_pk_bf16_f32 v110, v84, v85
    v_cvt_pk_bf16_f32 v111, v86, v87
    s_waitcnt lgkmcnt(0)
    v_mfma_f32_32x32x16_bf16 v[72:87], v[120:123], v[16:19], 0
    ds_read_b128 v[136:139], v1 offset:10240
    v_exp_f32 v88, v88
    v_exp_f32 v89, v89
    v_exp_f32 v90, v90
    v_exp_f32 v91, v91
    v_mfma_f32_32x32x16_bf16 v[72:87], v[124:127], v[20:23], v[72:87]
    ds_read_b128 v[140:143], v1 offset:11264
    v_exp_f32 v92, v92
    v_exp_f32 v93, v93
    v_exp_f32 v94, v94
    v_cvt_pk_bf16_f32 v112, v88, v89
    v_cvt_pk_bf16_f32 v113, v90, v91
    v_mfma_f32_32x32x16_bf16 v[32:47], v[144:147], v[104:107], v[32:47]
    v_exp_f32 v95, v95
    v_exp_f32 v96, v96
    v_exp_f32 v97, v97
    v_cvt_pk_bf16_f32 v114, v92, v93
    v_cvt_pk_bf16_f32 v115, v94, v95
    v_mfma_f32_32x32x16_bf16 v[32:47], v[148:151], v[108:111], v[32:47]
    v_exp_f32 v98, v98
    v_exp_f32 v99, v99
    v_exp_f32 v100, v100
    v_cvt_pk_bf16_f32 v116, v96, v97
    v_cvt_pk_bf16_f32 v117, v98, v99
    v_smfmac_f32_16x16x64_bf16 v[64:67], v[8:11], v[104:111], v12
    v_exp_f32 v101, v101
    v_exp_f32 v102, v102
    v_exp_f32 v103, v103
    v_cvt_pk_bf16_f32 v118, v100, v101
    v_cvt_pk_bf16_f32 v119, v102, v103
    v_mfma_f32_32x32x16_bf16 v[88:103], v[120:123], v[24:27], 0
    ds_read_b128 v[128:131], v1 offset:12288
    v_exp_f32 v72, v72
    v_exp_f32 v73, v73
    v_exp_f32 v74, v74
    v_exp_f32 v75, v75
    v_mfma_f32_32x32x16_bf16 v[88:103], v[124:127], v[28:31], v[88:103]
    ds_read_b128 v[132:135], v1 offset:13312
    v_exp_f32 v76, v76
    v_exp_f32 v77, v77
    v_exp_f32 v78, v78
    v_cvt_pk_bf16_f32 v104, v72, v73
    v_cvt_pk_bf16_f32 v105, v74, v75
    v_mfma_f32_32x32x16_bf16 v[48:63], v[144:147], v[112:115], v[48:63]
    v_exp_f32 v79, v79
    v_exp_f32 v80, v80
    v_exp_f32 v81, v81
    v_cvt_pk_bf16_f32 v106, v76, v77
    v_cvt_pk_bf16_f32 v107, v78, v79
    v_mfma_f32_32x32x16_bf16 v[48:63], v[148:151], v[116:119], v[48:63]
    v_exp_f32 v82, v82
    v_exp_f32 v83, v83
    v_exp_f32 v84, v84
    v_cvt_pk_bf16_f32 v108, v80, v81
    v_cvt_pk_bf16_f32 v109, v82, v83
    v_smfmac_f32_16x16x64_bf16 v[68:71], v[8:11], v[112:119], v12
    v_exp_f32 v85, v85
    v_exp_f32 v86, v86
    v_exp_f32 v87, v87
    v_cvt_pk_bf16_f32 v110, v84, v85
    v_cvt_pk_bf16_f32 v111, v86, v87
    s_waitcnt lgkmcnt(0)
    v_mfma_f32_32x32x16_bf16 v[72:87], v[128:131], v[16:19], 0
    ds_read_b128 v[144:147], v1 offset:14336
    v_exp_f32 v88, v88
    v_exp_f32 v89, v89
    v_exp_f32 v90, v90
    v_exp_f32 v91, v91
    v_mfma_f32_32x32x16_bf16 v[72:87], v[132:135], v[20:23], v[72:87]
    ds_read_b128 v[148:151], v1 offset:15360
    v_exp_f32 v92, v92
    v_exp_f32 v93, v93
    v_exp_f32 v94, v94
    v_cvt_pk_bf16_f32 v112, v88, v89
    v_cvt_pk_bf16_f32 v113, v90, v91
    v_mfma_f32_32x32x16_bf16 v[32:47], v[136:139], v[104:107], v[32:47]
    v_exp_f32 v95, v95
    v_exp_f32 v96, v96
    v_exp_f32 v97, v97
    v_cvt_pk_bf16_f32 v114, v92, v93
    v_cvt_pk_bf16_f32 v115, v94, v95
    v_mfma_f32_32x32x16_bf16 v[32:47], v[140:143], v[108:111], v[32:47]
    v_exp_f32 v98, v98
    v_exp_f32 v99, v99
    v_exp_f32 v100, v100
    v_cvt_pk_bf16_f32 v116, v96, v97
    v_cvt_pk_bf16_f32 v117, v98, v99
    v_smfmac_f32_16x16x64_bf16 v[64:67], v[8:11], v[104:111], v12
    v_exp_f32 v101, v101
    v_exp_f32 v102, v102
    v_exp_f32 v103, v103
    v_cvt_pk_bf16_f32 v118, v100, v101
    v_cvt_pk_bf16_f32 v119, v102, v103
    s_setprio 1
    v_mfma_f32_32x32x16_bf16 v[88:103], v[128:131], v[24:27], 0
    ds_read_b128 v[120:123], v1 offset:16384
    v_exp_f32 v72, v72
    v_exp_f32 v73, v73
    v_exp_f32 v74, v74
    v_exp_f32 v75, v75
    v_mfma_f32_32x32x16_bf16 v[88:103], v[132:135], v[28:31], v[88:103]
    ds_read_b128 v[124:127], v1 offset:17408
    v_exp_f32 v76, v76
    v_exp_f32 v77, v77
    v_exp_f32 v78, v78
    v_cvt_pk_bf16_f32 v104, v72, v73
    v_cvt_pk_bf16_f32 v105, v74, v75
    v_mfma_f32_32x32x16_bf16 v[48:63], v[136:139], v[112:115], v[48:63]
    v_exp_f32 v79, v79
    v_exp_f32 v80, v80
    v_exp_f32 v81, v81
    v_cvt_pk_bf16_f32 v106, v76, v77
    v_cvt_pk_bf16_f32 v107, v78, v79
    v_mfma_f32_32x32x16_bf16 v[48:63], v[140:143], v[116:119], v[48:63]
    v_exp_f32 v82, v82
    v_exp_f32 v83, v83
    v_exp_f32 v84, v84
    v_cvt_pk_bf16_f32 v108, v80, v81
    v_cvt_pk_bf16_f32 v109, v82, v83
    v_smfmac_f32_16x16x64_bf16 v[68:71], v[8:11], v[112:119], v12
    v_exp_f32 v85, v85
    v_exp_f32 v86, v86
    v_exp_f32 v87, v87
    v_cvt_pk_bf16_f32 v110, v84, v85
    v_cvt_pk_bf16_f32 v111, v86, v87
    s_waitcnt lgkmcnt(0)
    v_mfma_f32_32x32x16_bf16 v[72:87], v[120:123], v[16:19], 0
    ds_read_b128 v[136:139], v1 offset:18432
    v_exp_f32 v88, v88
    v_exp_f32 v89, v89
    v_exp_f32 v90, v90
    v_exp_f32 v91, v91
    v_mfma_f32_32x32x16_bf16 v[72:87], v[124:127], v[20:23], v[72:87]
    ds_read_b128 v[140:143], v1 offset:19456
    v_exp_f32 v92, v92
    v_exp_f32 v93, v93
    v_exp_f32 v94, v94
    v_cvt_pk_bf16_f32 v112, v88, v89
    v_cvt_pk_bf16_f32 v113, v90, v91
    v_mfma_f32_32x32x16_bf16 v[32:47], v[144:147], v[104:107], v[32:47]
    v_exp_f32 v95, v95
    v_exp_f32 v96, v96
    v_exp_f32 v97, v97
    v_cvt_pk_bf16_f32 v114, v92, v93
    v_cvt_pk_bf16_f32 v115, v94, v95
    v_mfma_f32_32x32x16_bf16 v[32:47], v[148:151], v[108:111], v[32:47]
    v_exp_f32 v98, v98
    v_exp_f32 v99, v99
    v_exp_f32 v100, v100
    v_cvt_pk_bf16_f32 v116, v96, v97
    v_cvt_pk_bf16_f32 v117, v98, v99
    v_smfmac_f32_16x16x64_bf16 v[64:67], v[8:11], v[104:111], v12
    v_exp_f32 v101, v101
    v_exp_f32 v102, v102
    v_exp_f32 v103, v103
    v_cvt_pk_bf16_f32 v118, v100, v101
    v_cvt_pk_bf16_f32 v119, v102, v103
    v_mfma_f32_32x32x16_bf16 v[88:103], v[120:123], v[24:27], 0
    ds_read_b128 v[128:131], v1 offset:20480
    v_exp_f32 v72, v72
    v_exp_f32 v73, v73
    v_exp_f32 v74, v74
    v_exp_f32 v75, v75
    v_mfma_f32_32x32x16_bf16 v[88:103], v[124:127], v[28:31], v[88:103]
    ds_read_b128 v[132:135], v1 offset:21504
    v_exp_f32 v76, v76
    v_exp_f32 v77, v77
    v_exp_f32 v78, v78
    v_cvt_pk_bf16_f32 v104, v72, v73
    v_cvt_pk_bf16_f32 v105, v74, v75
    v_mfma_f32_32x32x16_bf16 v[48:63], v[144:147], v[112:115], v[48:63]
    v_exp_f32 v79, v79
    v_exp_f32 v80, v80
    v_exp_f32 v81, v81
    v_cvt_pk_bf16_f32 v106, v76, v77
    v_cvt_pk_bf16_f32 v107, v78, v79
    v_mfma_f32_32x32x16_bf16 v[48:63], v[148:151], v[116:119], v[48:63]
    v_exp_f32 v82, v82
    v_exp_f32 v83, v83
    v_exp_f32 v84, v84
    v_cvt_pk_bf16_f32 v108, v80, v81
    v_cvt_pk_bf16_f32 v109, v82, v83
    v_smfmac_f32_16x16x64_bf16 v[68:71], v[8:11], v[112:119], v12
    v_exp_f32 v85, v85
    v_exp_f32 v86, v86
    v_exp_f32 v87, v87
    v_cvt_pk_bf16_f32 v110, v84, v85
    v_cvt_pk_bf16_f32 v111, v86, v87
    s_waitcnt lgkmcnt(0)
    v_mfma_f32_32x32x16_bf16 v[72:87], v[128:131], v[16:19], 0
    ds_read_b128 v[144:147], v1 offset:22528
    v_exp_f32 v88, v88
    v_exp_f32 v89, v89
    v_exp_f32 v90, v90
    v_exp_f32 v91, v91
    v_mfma_f32_32x32x16_bf16 v[72:87], v[132:135], v[20:23], v[72:87]
    ds_read_b128 v[148:151], v1 offset:23552
    v_exp_f32 v92, v92
    v_exp_f32 v93, v93
    v_exp_f32 v94, v94
    v_cvt_pk_bf16_f32 v112, v88, v89
    v_cvt_pk_bf16_f32 v113, v90, v91
    v_mfma_f32_32x32x16_bf16 v[32:47], v[136:139], v[104:107], v[32:47]
    v_exp_f32 v95, v95
    v_exp_f32 v96, v96
    v_exp_f32 v97, v97
    v_cvt_pk_bf16_f32 v114, v92, v93
    v_cvt_pk_bf16_f32 v115, v94, v95
    v_mfma_f32_32x32x16_bf16 v[32:47], v[140:143], v[108:111], v[32:47]
    v_exp_f32 v98, v98
    v_exp_f32 v99, v99
    v_exp_f32 v100, v100
    v_cvt_pk_bf16_f32 v116, v96, v97
    v_cvt_pk_bf16_f32 v117, v98, v99
    v_smfmac_f32_16x16x64_bf16 v[64:67], v[8:11], v[104:111], v12
    v_exp_f32 v101, v101
    v_exp_f32 v102, v102
    v_exp_f32 v103, v103
    v_cvt_pk_bf16_f32 v118, v100, v101
    v_cvt_pk_bf16_f32 v119, v102, v103
    s_setprio 0
    v_mfma_f32_32x32x16_bf16 v[88:103], v[128:131], v[24:27], 0
    ds_read_b128 v[120:123], v1 offset:24576
    v_exp_f32 v72, v72
    v_exp_f32 v73, v73
    v_exp_f32 v74, v74
    v_exp_f32 v75, v75
    v_mfma_f32_32x32x16_bf16 v[88:103], v[132:135], v[28:31], v[88:103]
    ds_read_b128 v[124:127], v1 offset:25600
    v_exp_f32 v76, v76
    v_exp_f32 v77, v77
    v_exp_f32 v78, v78
    v_cvt_pk_bf16_f32 v104, v72, v73
    v_cvt_pk_bf16_f32 v105, v74, v75
    v_mfma_f32_32x32x16_bf16 v[48:63], v[136:139], v[112:115], v[48:63]
    v_exp_f32 v79, v79
    v_exp_f32 v80, v80
    v_exp_f32 v81, v81
    v_cvt_pk_bf16_f32 v106, v76, v77
    v_cvt_pk_bf16_f32 v107, v78, v79
    v_mfma_f32_32x32x16_bf16 v[48:63], v[140:143], v[116:119], v[48:63]
    v_exp_f32 v82, v82
    v_exp_f32 v83, v83
    v_exp_f32 v84, v84
    v_cvt_pk_bf16_f32 v108, v80, v81
    v_cvt_pk_bf16_f32 v109, v82, v83
    v_smfmac_f32_16x16x64_bf16 v[68:71], v[8:11], v[112:119], v12
    v_exp_f32 v85, v85
    v_exp_f32 v86, v86
    v_exp_f32 v87, v87
    v_cvt_pk_bf16_f32 v110, v84, v85
    v_cvt_pk_bf16_f32 v111, v86, v87
    s_waitcnt lgkmcnt(0)
    v_mfma_f32_32x32x16_bf16 v[72:87], v[120:123], v[16:19], 0
    ds_read_b128 v[136:139], v1 offset:26624
    v_exp_f32 v88, v88
    v_exp_f32 v89, v89
    v_exp_f32 v90, v90
    v_exp_f32 v91, v91
    v_mfma_f32_32x32x16_bf16 v[72:87], v[124:127], v[20:23], v[72:87]
    ds_read_b128 v[140:143], v1 offset:27648
    v_exp_f32 v92, v92
    v_exp_f32 v93, v93
    v_exp_f32 v94, v94
    v_cvt_pk_bf16_f32 v112, v88, v89
    v_cvt_pk_bf16_f32 v113, v90, v91
    v_mfma_f32_32x32x16_bf16 v[32:47], v[144:147], v[104:107], v[32:47]
    v_exp_f32 v95, v95
    v_exp_f32 v96, v96
    v_exp_f32 v97, v97
    v_cvt_pk_bf16_f32 v114, v92, v93
    v_cvt_pk_bf16_f32 v115, v94, v95
    v_mfma_f32_32x32x16_bf16 v[32:47], v[148:151], v[108:111], v[32:47]
    v_exp_f32 v98, v98
    v_exp_f32 v99, v99
    v_exp_f32 v100, v100
    v_cvt_pk_bf16_f32 v116, v96, v97
    v_cvt_pk_bf16_f32 v117, v98, v99
    v_smfmac_f32_16x16x64_bf16 v[64:67], v[8:11], v[104:111], v12
    v_exp_f32 v101, v101
    v_exp_f32 v102, v102
    v_exp_f32 v103, v103
    v_cvt_pk_bf16_f32 v118, v100, v101
    v_cvt_pk_bf16_f32 v119, v102, v103
    v_mfma_f32_32x32x16_bf16 v[88:103], v[120:123], v[24:27], 0
    ds_read_b128 v[128:131], v1 offset:28672
    v_exp_f32 v72, v72
    v_exp_f32 v73, v73
    v_exp_f32 v74, v74
    v_exp_f32 v75, v75
    v_mfma_f32_32x32x16_bf16 v[88:103], v[124:127], v[28:31], v[88:103]
    ds_read_b128 v[132:135], v1 offset:29696
    v_exp_f32 v76, v76
    v_exp_f32 v77, v77
    v_exp_f32 v78, v78
    v_cvt_pk_bf16_f32 v104, v72, v73
    v_cvt_pk_bf16_f32 v105, v74, v75
    v_mfma_f32_32x32x16_bf16 v[48:63], v[144:147], v[112:115], v[48:63]
    v_exp_f32 v79, v79
    v_exp_f32 v80, v80
    v_exp_f32 v81, v81
    v_cvt_pk_bf16_f32 v106, v76, v77
    v_cvt_pk_bf16_f32 v107, v78, v79
    v_mfma_f32_32x32x16_bf16 v[48:63], v[148:151], v[116:119], v[48:63]
    v_exp_f32 v82, v82
    v_exp_f32 v83, v83
    v_exp_f32 v84, v84
    v_cvt_pk_bf16_f32 v108, v80, v81
    v_cvt_pk_bf16_f32 v109, v82, v83
    v_smfmac_f32_16x16x64_bf16 v[68:71], v[8:11], v[112:119], v12
    v_exp_f32 v85, v85
    v_exp_f32 v86, v86
    v_exp_f32 v87, v87
    v_cvt_pk_bf16_f32 v110, v84, v85
    v_cvt_pk_bf16_f32 v111, v86, v87
    s_waitcnt lgkmcnt(0)
    v_mfma_f32_32x32x16_bf16 v[72:87], v[128:131], v[16:19], 0
    ds_read_b128 v[144:147], v1 offset:30720
    v_exp_f32 v88, v88
    v_exp_f32 v89, v89
    v_exp_f32 v90, v90
    v_exp_f32 v91, v91
    v_mfma_f32_32x32x16_bf16 v[72:87], v[132:135], v[20:23], v[72:87]
    ds_read_b128 v[148:151], v1 offset:31744
    v_exp_f32 v92, v92
    v_exp_f32 v93, v93
    v_exp_f32 v94, v94
    v_cvt_pk_bf16_f32 v112, v88, v89
    v_cvt_pk_bf16_f32 v113, v90, v91
    v_mfma_f32_32x32x16_bf16 v[32:47], v[136:139], v[104:107], v[32:47]
    v_exp_f32 v95, v95
    v_exp_f32 v96, v96
    v_exp_f32 v97, v97
    v_cvt_pk_bf16_f32 v114, v92, v93
    v_cvt_pk_bf16_f32 v115, v94, v95
    v_mfma_f32_32x32x16_bf16 v[32:47], v[140:143], v[108:111], v[32:47]
    v_exp_f32 v98, v98
    v_exp_f32 v99, v99
    v_exp_f32 v100, v100
    v_cvt_pk_bf16_f32 v116, v96, v97
    v_cvt_pk_bf16_f32 v117, v98, v99
    v_smfmac_f32_16x16x64_bf16 v[64:67], v[8:11], v[104:111], v12
    v_exp_f32 v101, v101
    v_exp_f32 v102, v102
    v_exp_f32 v103, v103
    v_cvt_pk_bf16_f32 v118, v100, v101
    v_cvt_pk_bf16_f32 v119, v102, v103
    s_add_u32 s69, s69, 1
    s_cmp_lt_u32 s69, 8
    s_cbranch_scc1 L_att_loop
    v_mfma_f32_32x32x16_bf16 v[88:103], v[128:131], v[24:27], 0
    v_exp_f32 v72, v72
    v_exp_f32 v73, v73
    v_exp_f32 v74, v74
    v_exp_f32 v75, v75
    v_mfma_f32_32x32x16_bf16 v[88:103], v[132:135], v[28:31], v[88:103]
    v_exp_f32 v76, v76
    v_exp_f32 v77, v77
    v_exp_f32 v78, v78
    v_cvt_pk_bf16_f32 v104, v72, v73
    v_cvt_pk_bf16_f32 v105, v74, v75
    v_mfma_f32_32x32x16_bf16 v[48:63], v[136:139], v[112:115], v[48:63]
    v_exp_f32 v79, v79
    v_exp_f32 v80, v80
    v_exp_f32 v81, v81
    v_cvt_pk_bf16_f32 v106, v76, v77
    v_cvt_pk_bf16_f32 v107, v78, v79
    v_mfma_f32_32x32x16_bf16 v[48:63], v[140:143], v[116:119], v[48:63]
    v_exp_f32 v82, v82
    v_exp_f32 v83, v83
    v_exp_f32 v84, v84
    v_cvt_pk_bf16_f32 v108, v80, v81
    v_cvt_pk_bf16_f32 v109, v82, v83
    v_smfmac_f32_16x16x64_bf16 v[68:71], v[8:11], v[112:119], v12
    v_exp_f32 v85, v85
    v_exp_f32 v86, v86
    v_exp_f32 v87, v87
    v_cvt_pk_bf16_f32 v110, v84, v85
    v_cvt_pk_bf16_f32 v111, v86, v87
    s_waitcnt lgkmcnt(0)
    v_exp_f32 v88, v88
    v_exp_f32 v89, v89
    v_exp_f32 v90, v90
    v_exp_f32 v91, v91
    v_exp_f32 v92, v92
    v_exp_f32 v93, v93
    v_exp_f32 v94, v94
    v_cvt_pk_bf16_f32 v112, v88, v89
    v_cvt_pk_bf16_f32 v113, v90, v91
    v_mfma_f32_32x32x16_bf16 v[32:47], v[144:147], v[104:107], v[32:47]
    v_exp_f32 v95, v95
    v_exp_f32 v96, v96
    v_exp_f32 v97, v97
    v_cvt_pk_bf16_f32 v114, v92, v93
    v_cvt_pk_bf16_f32 v115, v94, v95
    v_mfma_f32_32x32x16_bf16 v[32:47], v[148:151], v[108:111], v[32:47]
    v_exp_f32 v98, v98
    v_exp_f32 v99, v99
    v_exp_f32 v100, v100
    v_cvt_pk_bf16_f32 v116, v96, v97
    v_cvt_pk_bf16_f32 v117, v98, v99
    v_smfmac_f32_16x16x64_bf16 v[64:67], v[8:11], v[104:111], v12
    v_exp_f32 v101, v101
    v_exp_f32 v102, v102
    v_exp_f32 v103, v103
    v_cvt_pk_bf16_f32 v118, v100, v101
    v_cvt_pk_bf16_f32 v119, v102, v103
    s_nop 1
    v_mfma_f32_32x32x16_bf16 v[48:63], v[144:147], v[112:115], v[48:63]
    v_mfma_f32_32x32x16_bf16 v[48:63], v[148:151], v[116:119], v[48:63]
    v_smfmac_f32_16x16x64_bf16 v[68:71], v[8:11], v[112:119], v12
    s_nop 15
    s_mov_b32 s78, 0x1f800000
    s_mov_b32 s79, 0x5f800000
    v_add_f32 v152, v64, v65
    v_mov_b32 v155, 0
    v_fma_f32 v155, v32, 0, v155
    v_fma_f32 v155, v33, 0, v155
    v_fma_f32 v155, v34, 0, v155
    v_fma_f32 v155, v35, 0, v155
    v_fma_f32 v155, v36, 0, v155
    v_fma_f32 v155, v37, 0, v155
    v_fma_f32 v155, v38, 0, v155
    v_fma_f32 v155, v39, 0, v155
    v_fma_f32 v155, v40, 0, v155
    v_fma_f32 v155, v41, 0, v155
    v_fma_f32 v155, v42, 0, v155
    v_fma_f32 v155, v43, 0, v155
    v_fma_f32 v155, v44, 0, v155
    v_fma_f32 v155, v45, 0, v155
    v_fma_f32 v155, v46, 0, v155
    v_fma_f32 v155, v47, 0, v155
    v_cmp_le_f32 vcc, s78, v152
    v_cmp_ge_f32 s[80:81], s79, v152
    v_cmp_o_f32 s[82:83], v155, v155
    s_nop 4
    s_and_b64 s[80:81], s[80:81], vcc
    s_and_b64 s[80:81], s[80:81], s[82:83]
    s_cmp_eq_u64 s[80:81], -1
    s_cbranch_scc1 L_rb_ok_1
    v_lshlrev_b32 v157, 4, v2
    s_lshl_b32 s60, s3, 18
    s_mov_b32 s62, 64
    v_mov_b32 v156, 0xff800000
L_slow1_2:
    buffer_load_dwordx4 v[120:123], v157, s[56:59], s60 offen sc1
    buffer_load_dwordx4 v[124:127], v157, s[56:59], s60 offen offset:1024 sc1
    s_waitcnt vmcnt(0)
    v_mfma_f32_32x32x16_bf16 v[72:87], v[120:123], v[16:19], 0
    v_mfma_f32_32x32x16_bf16 v[72:87], v[124:127], v[20:23], v[72:87]
    s_nop 15
    v_max3_f32 v156, v72, v73, v156
    v_max3_f32 v156, v74, v75, v156
    v_max3_f32 v156, v76, v77, v156
    v_max3_f32 v156, v78, v79, v156
    v_max3_f32 v156, v80, v81, v156
    v_max3_f32 v156, v82, v83, v156
    v_max3_f32 v156, v84, v85, v156
    v_max3_f32 v156, v86, v87, v156
    s_add_u32 s60, s60, 4096
    s_sub_u32 s62, s62, 1
    s_cmp_lg_u32 s62, 0
    s_cbranch_scc1 L_slow1_2
    v_mov_b32 v158, v156
    s_nop 1
    v_permlane32_swap_b32 v158, v156
    s_nop 1
    v_max_f32 v156, v156, v158
    v_sub_f32 v156, 0, v156
    v_mov_b32 v88, v156
    v_mov_b32 v89, v156
    v_mov_b32 v90, v156
    v_mov_b32 v91, v156
    v_mov_b32 v92, v156
    v_mov_b32 v93, v156
    v_mov_b32 v94, v156
    v_mov_b32 v95, v156
    v_mov_b32 v96, v156
    v_mov_b32 v97, v156
    v_mov_b32 v98, v156
    v_mov_b32 v99, v156
    v_mov_b32 v100, v156
    v_mov_b32 v101, v156
    v_mov_b32 v102, v156
    v_mov_b32 v103, v156
    v_mov_b32 v32, 0
    v_mov_b32 v33, 0
    v_mov_b32 v34, 0
    v_mov_b32 v35, 0
    v_mov_b32 v36, 0
    v_mov_b32 v37, 0
    v_mov_b32 v38, 0
    v_mov_b32 v39, 0
    v_mov_b32 v40, 0
    v_mov_b32 v41, 0
    v_mov_b32 v42, 0
    v_mov_b32 v43, 0
    v_mov_b32 v44, 0
    v_mov_b32 v45, 0
    v_mov_b32 v46, 0
    v_mov_b32 v47, 0
    v_mov_b32 v64, 0
    v_mov_b32 v65, 0
    v_mov_b32 v66, 0
    v_mov_b32 v67, 0
    s_lshl_b32 s60, s3, 18
    s_mov_b32 s62, 64
L_slow2_3:
    buffer_load_dwordx4 v[120:123], v157, s[56:59], s60 offen sc1
    buffer_load_dwordx4 v[124:127], v157, s[56:59], s60 offen offset:1024 sc1
    buffer_load_dwordx4 v[136:139], v157, s[56:59], s60 offen offset:2048 sc1
    buffer_load_dwordx4 v[140:143], v157, s[56:59], s60 offen offset:3072 sc1
    s_waitcnt vmcnt(0)
    v_mfma_f32_32x32x16_bf16 v[72:87], v[120:123], v[16:19], v[88:103]
    v_mfma_f32_32x32x16_bf16 v[72:87], v[124:127], v[20:23], v[72:87]
    s_nop 15
    v_exp_f32 v72, v72
    v_exp_f32 v73, v73
    v_exp_f32 v74, v74
    v_exp_f32 v75, v75
    v_exp_f32 v76, v76
    v_exp_f32 v77, v77
    v_exp_f32 v78, v78
    v_exp_f32 v79, v79
    v_exp_f32 v80, v80
    v_exp_f32 v81, v81
    v_exp_f32 v82, v82
    v_exp_f32 v83, v83
    v_exp_f32 v84, v84
    v_exp_f32 v85, v85
    v_exp_f32 v86, v86
    v_exp_f32 v87, v87
    s_nop 1
    v_cvt_pk_bf16_f32 v104, v72, v73
    v_cvt_pk_bf16_f32 v105, v74, v75
    v_cvt_pk_bf16_f32 v106, v76, v77
    v_cvt_pk_bf16_f32 v107, v78, v79
    v_cvt_pk_bf16_f32 v108, v80, v81
    v_cvt_pk_bf16_f32 v109, v82, v83
    v_cvt_pk_bf16_f32 v110, v84, v85
    v_cvt_pk_bf16_f32 v111, v86, v87
    s_nop 2
    v_mfma_f32_32x32x16_bf16 v[32:47], v[136:139], v[104:107], v[32:47]
    v_mfma_f32_32x32x16_bf16 v[32:47], v[140:143], v[108:111], v[32:47]
    v_smfmac_f32_16x16x64_bf16 v[64:67], v[8:11], v[104:111], v12
    s_nop 15
    s_add_u32 s60, s60, 4096
    s_sub_u32 s62, s62, 1
    s_cmp_lg_u32 s62, 0
    s_cbranch_scc1 L_slow2_3
    v_add_f32 v152, v64, v65
L_rb_ok_1:
    v_rcp_f32 v153, v152
    s_nop 0
    v_mul_f32 v32, v153, v32
    v_mul_f32 v33, v153, v33
    v_mul_f32 v34, v153, v34
    v_mul_f32 v35, v153, v35
    v_mul_f32 v36, v153, v36
    v_mul_f32 v37, v153, v37
    v_mul_f32 v38, v153, v38
    v_mul_f32 v39, v153, v39
    v_mul_f32 v40, v153, v40
    v_mul_f32 v41, v153, v41
    v_mul_f32 v42, v153, v42
    v_mul_f32 v43, v153, v43
    v_mul_f32 v44, v153, v44
    v_mul_f32 v45, v153, v45
    v_mul_f32 v46, v153, v46
    v_mul_f32 v47, v153, v47
    v_add_f32 v152, v68, v69
    v_mov_b32 v155, 0
    v_fma_f32 v155, v48, 0, v155
    v_fma_f32 v155, v49, 0, v155
    v_fma_f32 v155, v50, 0, v155
    v_fma_f32 v155, v51, 0, v155
    v_fma_f32 v155, v52, 0, v155
    v_fma_f32 v155, v53, 0, v155
    v_fma_f32 v155, v54, 0, v155
    v_fma_f32 v155, v55, 0, v155
    v_fma_f32 v155, v56, 0, v155
    v_fma_f32 v155, v57, 0, v155
    v_fma_f32 v155, v58, 0, v155
    v_fma_f32 v155, v59, 0, v155
    v_fma_f32 v155, v60, 0, v155
    v_fma_f32 v155, v61, 0, v155
    v_fma_f32 v155, v62, 0, v155
    v_fma_f32 v155, v63, 0, v155
    v_cmp_le_f32 vcc, s78, v152
    v_cmp_ge_f32 s[80:81], s79, v152
    v_cmp_o_f32 s[82:83], v155, v155
    s_nop 4
    s_and_b64 s[80:81], s[80:81], vcc
    s_and_b64 s[80:81], s[80:81], s[82:83]
    s_cmp_eq_u64 s[80:81], -1
    s_cbranch_scc1 L_rb_ok_4
    v_lshlrev_b32 v157, 4, v2
    s_lshl_b32 s60, s3, 18
    s_mov_b32 s62, 64
    v_mov_b32 v156, 0xff800000
L_slow1_5:
    buffer_load_dwordx4 v[120:123], v157, s[56:59], s60 offen sc1
    buffer_load_dwordx4 v[124:127], v157, s[56:59], s60 offen offset:1024 sc1
    s_waitcnt vmcnt(0)
    v_mfma_f32_32x32x16_bf16 v[72:87], v[120:123], v[24:27], 0
    v_mfma_f32_32x32x16_bf16 v[72:87], v[124:127], v[28:31], v[72:87]
    s_nop 15
    v_max3_f32 v156, v72, v73, v156
    v_max3_f32 v156, v74, v75, v156
    v_max3_f32 v156, v76, v77, v156
    v_max3_f32 v156, v78, v79, v156
    v_max3_f32 v156, v80, v81, v156
    v_max3_f32 v156, v82, v83, v156
    v_max3_f32 v156, v84, v85, v156
    v_max3_f32 v156, v86, v87, v156
    s_add_u32 s60, s60, 4096
    s_sub_u32 s62, s62, 1
    s_cmp_lg_u32 s62, 0
    s_cbranch_scc1 L_slow1_5
    v_mov_b32 v158, v156
    s_nop 1
    v_permlane32_swap_b32 v158, v156
    s_nop 1
    v_max_f32 v156, v156, v158
    v_sub_f32 v156, 0, v156
    v_mov_b32 v88, v156
    v_mov_b32 v89, v156
    v_mov_b32 v90, v156
    v_mov_b32 v91, v156
    v_mov_b32 v92, v156
    v_mov_b32 v93, v156
    v_mov_b32 v94, v156
    v_mov_b32 v95, v156
    v_mov_b32 v96, v156
    v_mov_b32 v97, v156
    v_mov_b32 v98, v156
    v_mov_b32 v99, v156
    v_mov_b32 v100, v156
    v_mov_b32 v101, v156
    v_mov_b32 v102, v156
    v_mov_b32 v103, v156
    v_mov_b32 v48, 0
    v_mov_b32 v49, 0
    v_mov_b32 v50, 0
    v_mov_b32 v51, 0
    v_mov_b32 v52, 0
    v_mov_b32 v53, 0
    v_mov_b32 v54, 0
    v_mov_b32 v55, 0
    v_mov_b32 v56, 0
    v_mov_b32 v57, 0
    v_mov_b32 v58, 0
    v_mov_b32 v59, 0
    v_mov_b32 v60, 0
    v_mov_b32 v61, 0
    v_mov_b32 v62, 0
    v_mov_b32 v63, 0
    v_mov_b32 v68, 0
    v_mov_b32 v69, 0
    v_mov_b32 v70, 0
    v_mov_b32 v71, 0
    s_lshl_b32 s60, s3, 18
    s_mov_b32 s62, 64
L_slow2_6:
    buffer_load_dwordx4 v[120:123], v157, s[56:59], s60 offen sc1
    buffer_load_dwordx4 v[124:127], v157, s[56:59], s60 offen offset:1024 sc1
    buffer_load_dwordx4 v[136:139], v157, s[56:59], s60 offen offset:2048 sc1
    buffer_load_dwordx4 v[140:143], v157, s[56:59], s60 offen offset:3072 sc1
    s_waitcnt vmcnt(0)
    v_mfma_f32_32x32x16_bf16 v[72:87], v[120:123], v[24:27], v[88:103]
    v_mfma_f32_32x32x16_bf16 v[72:87], v[124:127], v[28:31], v[72:87]
    s_nop 15
    v_exp_f32 v72, v72
    v_exp_f32 v73, v73
    v_exp_f32 v74, v74
    v_exp_f32 v75, v75
    v_exp_f32 v76, v76
    v_exp_f32 v77, v77
    v_exp_f32 v78, v78
    v_exp_f32 v79, v79
    v_exp_f32 v80, v80
    v_exp_f32 v81, v81
    v_exp_f32 v82, v82
    v_exp_f32 v83, v83
    v_exp_f32 v84, v84
    v_exp_f32 v85, v85
    v_exp_f32 v86, v86
    v_exp_f32 v87, v87
    s_nop 1
    v_cvt_pk_bf16_f32 v104, v72, v73
    v_cvt_pk_bf16_f32 v105, v74, v75
    v_cvt_pk_bf16_f32 v106, v76, v77
    v_cvt_pk_bf16_f32 v107, v78, v79
    v_cvt_pk_bf16_f32 v108, v80, v81
    v_cvt_pk_bf16_f32 v109, v82, v83
    v_cvt_pk_bf16_f32 v110, v84, v85
    v_cvt_pk_bf16_f32 v111, v86, v87
    s_nop 2
    v_mfma_f32_32x32x16_bf16 v[48:63], v[136:139], v[104:107], v[48:63]
    v_mfma_f32_32x32x16_bf16 v[48:63], v[140:143], v[108:111], v[48:63]
    v_smfmac_f32_16x16x64_bf16 v[68:71], v[8:11], v[104:111], v12
    s_nop 15
    s_add_u32 s60, s60, 4096
    s_sub_u32 s62, s62, 1
    s_cmp_lg_u32 s62, 0
    s_cbranch_scc1 L_slow2_6
    v_add_f32 v152, v68, v69
L_rb_ok_4:
    v_rcp_f32 v153, v152
    s_nop 0
    v_mul_f32 v48, v153, v48
    v_mul_f32 v49, v153, v49
    v_mul_f32 v50, v153, v50
    v_mul_f32 v51, v153, v51
    v_mul_f32 v52, v153, v52
    v_mul_f32 v53, v153, v53
    v_mul_f32 v54, v153, v54
    v_mul_f32 v55, v153, v55
    v_mul_f32 v56, v153, v56
    v_mul_f32 v57, v153, v57
    v_mul_f32 v58, v153, v58
    v_mul_f32 v59, v153, v59
    v_mul_f32 v60, v153, v60
    v_mul_f32 v61, v153, v61
    v_mul_f32 v62, v153, v62
    v_mul_f32 v63, v153, v63
    v_lshlrev_b32 v154, 4, v2
    v_cvt_pk_bf16_f32 v72, v32, v33
    v_cvt_pk_bf16_f32 v73, v34, v35
    v_cvt_pk_bf16_f32 v74, v36, v37
    v_cvt_pk_bf16_f32 v75, v38, v39
    v_cvt_pk_bf16_f32 v76, v40, v41
    v_cvt_pk_bf16_f32 v77, v42, v43
    v_cvt_pk_bf16_f32 v78, v44, v45
    v_cvt_pk_bf16_f32 v79, v46, v47
    buffer_store_dwordx4 v[72:75], v154, s[56:59], s61 offen offset:0 sc1
    buffer_store_dwordx4 v[76:79], v154, s[56:59], s61 offen offset:1024 sc1
    v_cvt_pk_bf16_f32 v88, v48, v49
    v_cvt_pk_bf16_f32 v89, v50, v51
    v_cvt_pk_bf16_f32 v90, v52, v53
    v_cvt_pk_bf16_f32 v91, v54, v55
    v_cvt_pk_bf16_f32 v92, v56, v57
    v_cvt_pk_bf16_f32 v93, v58, v59
    v_cvt_pk_bf16_f32 v94, v60, v61
    v_cvt_pk_bf16_f32 v95, v62, v63
    buffer_store_dwordx4 v[88:91], v154, s[56:59], s61 offen offset:2048 sc1
    buffer_store_dwordx4 v[92:95], v154, s[56:59], s61 offen offset:3072 sc1
    s_lshr_b32 s60, s6, 2
    s_cmp_eq_u32 s60, 0
    s_cselect_b32 s60, 131072, 0
    s_add_u32 s60, s60, 16384
    s_and_b32 s62, s6, 3
    s_lshl_b32 s62, s62, 12
    s_add_u32 s60, s60, s62
    v_add_u32 v155, s60, v154
    ds_write_b128 v155, v[72:75] offset:0
    ds_write_b128 v155, v[76:79] offset:1024
    ds_write_b128 v155, v[88:91] offset:2048
    ds_write_b128 v155, v[92:95] offset:3072
    v_bfe_u32 v124, v2, 2, 2
    v_lshrrev_b32 v125, 4, v2
    v_lshrrev_b32 v126, 1, v125
    v_lshlrev_b32 v126, 4, v126
    v_and_b32 v127, 1, v125
    v_lshl_add_u32 v126, v127, 2, v126
    v_add_u32 v126, v126, v124
    v_lshlrev_b32 v126, 8, v126
    v_and_b32 v127, 3, v2
    v_lshl_add_u32 v126, v127, 3, v126
    v_lshlrev_b32 v124, 1, v124
    v_and_b32 v125, 1, v125
    v_xor_b32 v124, v124, v125
    s_lshr_b32 s70, s6, 2
    s_lshl_b32 s70, s70, 2
    v_xor_b32 v124, s70, v124
    v_add_u32 v126, 131072, v126
    v_xor_b32 v125, 0, v124
    v_lshl_add_u32 v128, v125, 5, v126
    v_xor_b32 v125, 1, v124
    v_lshl_add_u32 v129, v125, 5, v126
    v_xor_b32 v125, 2, v124
    v_lshl_add_u32 v130, v125, 5, v126
    v_xor_b32 v125, 3, v124
    v_lshl_add_u32 v131, v125, 5, v126
    s_and_b32 s70, s6, 3
    s_lshl_b32 s70, s70, 12
    s_add_u32 s70, s70, 147456
    v_and_b32 v124, 15, v2
    v_lshlrev_b32 v124, 4, v124
    v_lshrrev_b32 v125, 5, v2
    v_lshl_add_u32 v124, v125, 10, v124
    v_bfe_u32 v125, v2, 4, 1
    v_lshl_add_u32 v124, v125, 9, v124
    v_add_u32 v132, s70, v124
    s_mov_b32 s75, 131072
    v_mov_b32 v32, 0
    v_mov_b32 v33, 0
    v_mov_b32 v34, 0
    v_mov_b32 v35, 0
    v_mov_b32 v36, 0
    v_mov_b32 v37, 0
    v_mov_b32 v38, 0
    v_mov_b32 v39, 0
    v_mov_b32 v40, 0
    v_mov_b32 v41, 0
    v_mov_b32 v42, 0
    v_mov_b32 v43, 0
    v_mov_b32 v44, 0
    v_mov_b32 v45, 0
    v_mov_b32 v46, 0
    v_mov_b32 v47, 0
    v_mov_b32 v48, 0
    v_mov_b32 v49, 0
    v_mov_b32 v50, 0
    v_mov_b32 v51, 0
    v_mov_b32 v52, 0
    v_mov_b32 v53, 0
    v_mov_b32 v54, 0
    v_mov_b32 v55, 0
    v_mov_b32 v56, 0
    v_mov_b32 v57, 0
    v_mov_b32 v58, 0
    v_mov_b32 v59, 0
    v_mov_b32 v60, 0
    v_mov_b32 v61, 0
    v_mov_b32 v62, 0
    v_mov_b32 v63, 0
    s_waitcnt vmcnt(0) lgkmcnt(0)
    s_barrier
    ds_read_b128 v[104:107], v132 offset:0
    ds_read_b128 v[108:111], v132 offset:256
    ds_read_b64_tr_b16 v[72:73], v128 offset:0
    ds_read_b64_tr_b16 v[74:75], v129 offset:2048
    ds_read_b64_tr_b16 v[76:77], v129 offset:0
    ds_read_b64_tr_b16 v[78:79], v128 offset:2048
    ds_read_b64_tr_b16 v[80:81], v130 offset:0
    ds_read_b64_tr_b16 v[82:83], v131 offset:2048
    ds_read_b64_tr_b16 v[84:85], v131 offset:0
    ds_read_b64_tr_b16 v[86:87], v130 offset:2048
    s_setprio 3
    s_waitcnt lgkmcnt(0)
    v_mfma_f32_16x16x32_bf16 v[32:35], v[72:75], v[104:107], v[32:35]
    ds_read_b128 v[112:115], v132 offset:2048
    ds_read_b128 v[116:119], v132 offset:2304
    v_mfma_f32_16x16x32_bf16 v[36:39], v[72:75], v[108:111], v[36:39]
    ds_read_b64_tr_b16 v[88:89], v128 offset:8192
    v_mfma_f32_16x16x32_bf16 v[40:43], v[76:79], v[104:107], v[40:43]
    ds_read_b64_tr_b16 v[90:91], v129 offset:10240
    ds_read_b64_tr_b16 v[92:93], v129 offset:8192
    v_mfma_f32_16x16x32_bf16 v[44:47], v[76:79], v[108:111], v[44:47]
    ds_read_b64_tr_b16 v[94:95], v128 offset:10240
    v_mfma_f32_16x16x32_bf16 v[48:51], v[80:83], v[104:107], v[48:51]
    ds_read_b64_tr_b16 v[96:97], v130 offset:8192
    v_mfma_f32_16x16x32_bf16 v[52:55], v[80:83], v[108:111], v[52:55]
    ds_read_b64_tr_b16 v[98:99], v131 offset:10240
    v_mfma_f32_16x16x32_bf16 v[56:59], v[84:87], v[104:107], v[56:59]
    ds_read_b64_tr_b16 v[100:101], v131 offset:8192
    v_mfma_f32_16x16x32_bf16 v[60:63], v[84:87], v[108:111], v[60:63]
    ds_read_b64_tr_b16 v[102:103], v130 offset:10240
    s_add_u32 s70, s75, 32768
    s_cmp_eq_u32 s70, 163840
    s_cselect_b32 s70, 0, s70
    s_sub_u32 s76, s70, s75
    s_mov_b32 s75, s70
    v_add_u32 v128, s76, v128
    v_add_u32 v129, s76, v129
    v_add_u32 v130, s76, v130
    v_add_u32 v131, s76, v131
    v_add_u32 v132, s76, v132
    s_setprio 1
    s_waitcnt lgkmcnt(0)
    v_mfma_f32_16x16x32_bf16 v[32:35], v[88:91], v[112:115], v[32:35]
    ds_read_b128 v[104:107], v132 offset:0
    ds_read_b128 v[108:111], v132 offset:256
    v_mfma_f32_16x16x32_bf16 v[36:39], v[88:91], v[116:119], v[36:39]
    ds_read_b64_tr_b16 v[72:73], v128 offset:0
    v_mfma_f32_16x16x32_bf16 v[40:43], v[92:95], v[112:115], v[40:43]
    ds_read_b64_tr_b16 v[74:75], v129 offset:2048
    ds_read_b64_tr_b16 v[76:77], v129 offset:0
    v_mfma_f32_16x16x32_bf16 v[44:47], v[92:95], v[116:119], v[44:47]
    ds_read_b64_tr_b16 v[78:79], v128 offset:2048
    v_mfma_f32_16x16x32_bf16 v[48:51], v[96:99], v[112:115], v[48:51]
    ds_read_b64_tr_b16 v[80:81], v130 offset:0
    v_mfma_f32_16x16x32_bf16 v[52:55], v[96:99], v[116:119], v[52:55]
    ds_read_b64_tr_b16 v[82:83], v131 offset:2048
    v_mfma_f32_16x16x32_bf16 v[56:59], v[100:103], v[112:115], v[56:59]
    ds_read_b64_tr_b16 v[84:85], v131 offset:0
    v_mfma_f32_16x16x32_bf16 v[60:63], v[100:103], v[116:119], v[60:63]
    ds_read_b64_tr_b16 v[86:87], v130 offset:2048
    s_setprio 3
    s_waitcnt lgkmcnt(0)
    v_mfma_f32_16x16x32_bf16 v[32:35], v[72:75], v[104:107], v[32:35]
    ds_read_b128 v[112:115], v132 offset:2048
    ds_read_b128 v[116:119], v132 offset:2304
    v_mfma_f32_16x16x32_bf16 v[36:39], v[72:75], v[108:111], v[36:39]
    ds_read_b64_tr_b16 v[88:89], v128 offset:8192
    v_mfma_f32_16x16x32_bf16 v[40:43], v[76:79], v[104:107], v[40:43]
    ds_read_b64_tr_b16 v[90:91], v129 offset:10240
    ds_read_b64_tr_b16 v[92:93], v129 offset:8192
    v_mfma_f32_16x16x32_bf16 v[44:47], v[76:79], v[108:111], v[44:47]
    ds_read_b64_tr_b16 v[94:95], v128 offset:10240
    v_mfma_f32_16x16x32_bf16 v[48:51], v[80:83], v[104:107], v[48:51]
    ds_read_b64_tr_b16 v[96:97], v130 offset:8192
    v_mfma_f32_16x16x32_bf16 v[52:55], v[80:83], v[108:111], v[52:55]
    ds_read_b64_tr_b16 v[98:99], v131 offset:10240
    v_mfma_f32_16x16x32_bf16 v[56:59], v[84:87], v[104:107], v[56:59]
    ds_read_b64_tr_b16 v[100:101], v131 offset:8192
    v_mfma_f32_16x16x32_bf16 v[60:63], v[84:87], v[108:111], v[60:63]
    ds_read_b64_tr_b16 v[102:103], v130 offset:10240
    s_setprio 1
    s_waitcnt lgkmcnt(0)
    v_mfma_f32_16x16x32_bf16 v[32:35], v[88:91], v[112:115], v[32:35]
    v_mfma_f32_16x16x32_bf16 v[36:39], v[88:91], v[116:119], v[36:39]
    v_mfma_f32_16x16x32_bf16 v[40:43], v[92:95], v[112:115], v[40:43]
    v_mfma_f32_16x16x32_bf16 v[44:47], v[92:95], v[116:119], v[44:47]
    v_mfma_f32_16x16x32_bf16 v[48:51], v[96:99], v[112:115], v[48:51]
    v_mfma_f32_16x16x32_bf16 v[52:55], v[96:99], v[116:119], v[52:55]
    v_mfma_f32_16x16x32_bf16 v[56:59], v[100:103], v[112:115], v[56:59]
    v_mfma_f32_16x16x32_bf16 v[60:63], v[100:103], v[116:119], v[60:63]
    s_add_u32 s70, s75, 32768
    s_cmp_eq_u32 s70, 163840
    s_cselect_b32 s70, 0, s70
    s_sub_u32 s76, s70, s75
    s_mov_b32 s75, s70
    v_add_u32 v128, s76, v128
    v_add_u32 v129, s76, v129
    v_add_u32 v130, s76, v130
    v_add_u32 v131, s76, v131
    v_add_u32 v132, s76, v132
    s_barrier
    ds_read_b128 v[104:107], v132 offset:0
    ds_read_b128 v[108:111], v132 offset:256
    ds_read_b64_tr_b16 v[72:73], v128 offset:0
    ds_read_b64_tr_b16 v[74:75], v129 offset:2048
    ds_read_b64_tr_b16 v[76:77], v129 offset:0
    ds_read_b64_tr_b16 v[78:79], v128 offset:2048
    ds_read_b64_tr_b16 v[80:81], v130 offset:0
    ds_read_b64_tr_b16 v[82:83], v131 offset:2048
    ds_read_b64_tr_b16 v[84:85], v131 offset:0
    ds_read_b64_tr_b16 v[86:87], v130 offset:2048
    s_setprio 3
    s_waitcnt lgkmcnt(0)
    v_mfma_f32_16x16x32_bf16 v[32:35], v[72:75], v[104:107], v[32:35]
    ds_read_b128 v[112:115], v132 offset:2048
    ds_read_b128 v[116:119], v132 offset:2304
    v_mfma_f32_16x16x32_bf16 v[36:39], v[72:75], v[108:111], v[36:39]
    ds_read_b64_tr_b16 v[88:89], v128 offset:8192
    v_mfma_f32_16x16x32_bf16 v[40:43], v[76:79], v[104:107], v[40:43]
    ds_read_b64_tr_b16 v[90:91], v129 offset:10240
    ds_read_b64_tr_b16 v[92:93], v129 offset:8192
    v_mfma_f32_16x16x32_bf16 v[44:47], v[76:79], v[108:111], v[44:47]
    ds_read_b64_tr_b16 v[94:95], v128 offset:10240
    v_mfma_f32_16x16x32_bf16 v[48:51], v[80:83], v[104:107], v[48:51]
    ds_read_b64_tr_b16 v[96:97], v130 offset:8192
    v_mfma_f32_16x16x32_bf16 v[52:55], v[80:83], v[108:111], v[52:55]
    ds_read_b64_tr_b16 v[98:99], v131 offset:10240
    v_mfma_f32_16x16x32_bf16 v[56:59], v[84:87], v[104:107], v[56:59]
    ds_read_b64_tr_b16 v[100:101], v131 offset:8192
    v_mfma_f32_16x16x32_bf16 v[60:63], v[84:87], v[108:111], v[60:63]
    ds_read_b64_tr_b16 v[102:103], v130 offset:10240
    s_add_u32 s70, s75, 32768
    s_cmp_eq_u32 s70, 163840
    s_cselect_b32 s70, 0, s70
    s_sub_u32 s76, s70, s75
    s_mov_b32 s75, s70
    v_add_u32 v128, s76, v128
    v_add_u32 v129, s76, v129
    v_add_u32 v130, s76, v130
    v_add_u32 v131, s76, v131
    v_add_u32 v132, s76, v132
    s_setprio 1
    s_waitcnt lgkmcnt(0)
    v_mfma_f32_16x16x32_bf16 v[32:35], v[88:91], v[112:115], v[32:35]
    ds_read_b128 v[104:107], v132 offset:0
    ds_read_b128 v[108:111], v132 offset:256
    v_mfma_f32_16x16x32_bf16 v[36:39], v[88:91], v[116:119], v[36:39]
    ds_read_b64_tr_b16 v[72:73], v128 offset:0
    v_mfma_f32_16x16x32_bf16 v[40:43], v[92:95], v[112:115], v[40:43]
    ds_read_b64_tr_b16 v[74:75], v129 offset:2048
    ds_read_b64_tr_b16 v[76:77], v129 offset:0
    v_mfma_f32_16x16x32_bf16 v[44:47], v[92:95], v[116:119], v[44:47]
    ds_read_b64_tr_b16 v[78:79], v128 offset:2048
    v_mfma_f32_16x16x32_bf16 v[48:51], v[96:99], v[112:115], v[48:51]
    ds_read_b64_tr_b16 v[80:81], v130 offset:0
    v_mfma_f32_16x16x32_bf16 v[52:55], v[96:99], v[116:119], v[52:55]
    ds_read_b64_tr_b16 v[82:83], v131 offset:2048
    v_mfma_f32_16x16x32_bf16 v[56:59], v[100:103], v[112:115], v[56:59]
    ds_read_b64_tr_b16 v[84:85], v131 offset:0
    v_mfma_f32_16x16x32_bf16 v[60:63], v[100:103], v[116:119], v[60:63]
    ds_read_b64_tr_b16 v[86:87], v130 offset:2048
    s_mov_b32 s69, 12
.p2align 6
L_o_loop:
    s_barrier
    s_setprio 3
    s_waitcnt lgkmcnt(0)
    v_mfma_f32_16x16x32_bf16 v[32:35], v[72:75], v[104:107], v[32:35]
    ds_read_b128 v[112:115], v132 offset:2048
    ds_read_b128 v[116:119], v132 offset:2304
    v_mfma_f32_16x16x32_bf16 v[36:39], v[72:75], v[108:111], v[36:39]
    ds_read_b64_tr_b16 v[88:89], v128 offset:8192
    v_mfma_f32_16x16x32_bf16 v[40:43], v[76:79], v[104:107], v[40:43]
    ds_read_b64_tr_b16 v[90:91], v129 offset:10240
    ds_read_b64_tr_b16 v[92:93], v129 offset:8192
    v_mfma_f32_16x16x32_bf16 v[44:47], v[76:79], v[108:111], v[44:47]
    ds_read_b64_tr_b16 v[94:95], v128 offset:10240
    v_mfma_f32_16x16x32_bf16 v[48:51], v[80:83], v[104:107], v[48:51]
    ds_read_b64_tr_b16 v[96:97], v130 offset:8192
    v_mfma_f32_16x16x32_bf16 v[52:55], v[80:83], v[108:111], v[52:55]
    ds_read_b64_tr_b16 v[98:99], v131 offset:10240
    v_mfma_f32_16x16x32_bf16 v[56:59], v[84:87], v[104:107], v[56:59]
    ds_read_b64_tr_b16 v[100:101], v131 offset:8192
    v_mfma_f32_16x16x32_bf16 v[60:63], v[84:87], v[108:111], v[60:63]
    ds_read_b64_tr_b16 v[102:103], v130 offset:10240
    s_add_u32 s70, s75, 32768
    s_cmp_eq_u32 s70, 163840
    s_cselect_b32 s70, 0, s70
    s_sub_u32 s76, s70, s75
    s_mov_b32 s75, s70
    v_add_u32 v128, s76, v128
    v_add_u32 v129, s76, v129
    v_add_u32 v130, s76, v130
    v_add_u32 v131, s76, v131
    v_add_u32 v132, s76, v132
    s_setprio 1
    s_waitcnt lgkmcnt(0)
    v_mfma_f32_16x16x32_bf16 v[32:35], v[88:91], v[112:115], v[32:35]
    ds_read_b128 v[104:107], v132 offset:0
    ds_read_b128 v[108:111], v132 offset:256
    v_mfma_f32_16x16x32_bf16 v[36:39], v[88:91], v[116:119], v[36:39]
    ds_read_b64_tr_b16 v[72:73], v128 offset:0
    v_mfma_f32_16x16x32_bf16 v[40:43], v[92:95], v[112:115], v[40:43]
    ds_read_b64_tr_b16 v[74:75], v129 offset:2048
    ds_read_b64_tr_b16 v[76:77], v129 offset:0
    v_mfma_f32_16x16x32_bf16 v[44:47], v[92:95], v[116:119], v[44:47]
    ds_read_b64_tr_b16 v[78:79], v128 offset:2048
    v_mfma_f32_16x16x32_bf16 v[48:51], v[96:99], v[112:115], v[48:51]
    ds_read_b64_tr_b16 v[80:81], v130 offset:0
    v_mfma_f32_16x16x32_bf16 v[52:55], v[96:99], v[116:119], v[52:55]
    ds_read_b64_tr_b16 v[82:83], v131 offset:2048
    v_mfma_f32_16x16x32_bf16 v[56:59], v[100:103], v[112:115], v[56:59]
    ds_read_b64_tr_b16 v[84:85], v131 offset:0
    v_mfma_f32_16x16x32_bf16 v[60:63], v[100:103], v[116:119], v[60:63]
    ds_read_b64_tr_b16 v[86:87], v130 offset:2048
    s_sub_u32 s69, s69, 1
    s_cmp_lg_u32 s69, 0
    s_cbranch_scc1 L_o_loop
    s_setprio 3
    s_waitcnt lgkmcnt(0)
    v_mfma_f32_16x16x32_bf16 v[32:35], v[72:75], v[104:107], v[32:35]
    ds_read_b128 v[112:115], v132 offset:2048
    ds_read_b128 v[116:119], v132 offset:2304
    v_mfma_f32_16x16x32_bf16 v[36:39], v[72:75], v[108:111], v[36:39]
    ds_read_b64_tr_b16 v[88:89], v128 offset:8192
    v_mfma_f32_16x16x32_bf16 v[40:43], v[76:79], v[104:107], v[40:43]
    ds_read_b64_tr_b16 v[90:91], v129 offset:10240
    ds_read_b64_tr_b16 v[92:93], v129 offset:8192
    v_mfma_f32_16x16x32_bf16 v[44:47], v[76:79], v[108:111], v[44:47]
    ds_read_b64_tr_b16 v[94:95], v128 offset:10240
    v_mfma_f32_16x16x32_bf16 v[48:51], v[80:83], v[104:107], v[48:51]
    ds_read_b64_tr_b16 v[96:97], v130 offset:8192
    v_mfma_f32_16x16x32_bf16 v[52:55], v[80:83], v[108:111], v[52:55]
    ds_read_b64_tr_b16 v[98:99], v131 offset:10240
    v_mfma_f32_16x16x32_bf16 v[56:59], v[84:87], v[104:107], v[56:59]
    ds_read_b64_tr_b16 v[100:101], v131 offset:8192
    v_mfma_f32_16x16x32_bf16 v[60:63], v[84:87], v[108:111], v[60:63]
    ds_read_b64_tr_b16 v[102:103], v130 offset:10240
    s_setprio 1
    s_waitcnt lgkmcnt(0)
    v_mfma_f32_16x16x32_bf16 v[32:35], v[88:91], v[112:115], v[32:35]
    v_mfma_f32_16x16x32_bf16 v[36:39], v[88:91], v[116:119], v[36:39]
    v_mfma_f32_16x16x32_bf16 v[40:43], v[92:95], v[112:115], v[40:43]
    v_mfma_f32_16x16x32_bf16 v[44:47], v[92:95], v[116:119], v[44:47]
    v_mfma_f32_16x16x32_bf16 v[48:51], v[96:99], v[112:115], v[48:51]
    v_mfma_f32_16x16x32_bf16 v[52:55], v[96:99], v[116:119], v[52:55]
    v_mfma_f32_16x16x32_bf16 v[56:59], v[100:103], v[112:115], v[56:59]
    v_mfma_f32_16x16x32_bf16 v[60:63], v[100:103], v[116:119], v[60:63]
    s_setprio 0
    s_lshl_b32 s7, s4, 7
    s_and_b32 s60, s6, 3
    s_lshl_b32 s60, s60, 5
    s_add_u32 s7, s7, s60
    s_lshl_b32 s7, s7, 12
    s_lshl_b32 s60, s3, 11
    s_add_u32 s7, s7, s60
    s_lshl_b32 s60, s5, 8
    s_add_u32 s7, s7, s60
    s_lshr_b32 s60, s6, 2
    s_lshl_b32 s60, s60, 7
    s_add_u32 s7, s7, s60
    s_mul_i32 s60, s6, 4608
    s_add_u32 s60, s60, 32768
    v_and_b32 v124, 15, v2
    v_mul_u32_u24 v124, 144, v124
    v_lshrrev_b32 v125, 4, v2
    v_lshl_add_u32 v124, v125, 3, v124
    v_add_u32 v124, s60, v124
    v_lshrrev_b32 v125, 3, v2
    v_mul_u32_u24 v126, 144, v125
    v_and_b32 v127, 7, v2
    v_lshl_add_u32 v126, v127, 4, v126
    v_add_u32 v126, s60, v126
    v_lshlrev_b32 v125, 12, v125
    v_lshl_add_u32 v125, v127, 4, v125
    v_cvt_pk_bf16_f32 v72, v32, v33
    v_cvt_pk_bf16_f32 v73, v34, v35
    v_cvt_pk_bf16_f32 v74, v36, v37
    v_cvt_pk_bf16_f32 v75, v38, v39
    v_cvt_pk_bf16_f32 v76, v40, v41
    v_cvt_pk_bf16_f32 v77, v42, v43
    v_cvt_pk_bf16_f32 v78, v44, v45
    v_cvt_pk_bf16_f32 v79, v46, v47
    v_cvt_pk_bf16_f32 v80, v48, v49
    v_cvt_pk_bf16_f32 v81, v50, v51
    v_cvt_pk_bf16_f32 v82, v52, v53
    v_cvt_pk_bf16_f32 v83, v54, v55
    v_cvt_pk_bf16_f32 v84, v56, v57
    v_cvt_pk_bf16_f32 v85, v58, v59
    v_cvt_pk_bf16_f32 v86, v60, v61
    v_cvt_pk_bf16_f32 v87, v62, v63
    ds_write_b64 v124, v[72:73] offset:0
    ds_write_b64 v124, v[74:75] offset:2304
    ds_write_b64 v124, v[76:77] offset:32
    ds_write_b64 v124, v[78:79] offset:2336
    ds_write_b64 v124, v[80:81] offset:64
    ds_write_b64 v124, v[82:83] offset:2368
    ds_write_b64 v124, v[84:85] offset:96
    ds_write_b64 v124, v[86:87] offset:2400
    s_waitcnt lgkmcnt(0)
    ds_read_b128 v[104:107], v126 offset:0
    ds_read_b128 v[108:111], v126 offset:1152
    ds_read_b128 v[112:115], v126 offset:2304
    ds_read_b128 v[116:119], v126 offset:3456
    s_waitcnt lgkmcnt(3)
    buffer_store_dwordx4 v[104:107], v125, s[84:87], s7 offen nt
    s_add_u32 s7, s7, 32768
    s_waitcnt lgkmcnt(2)
    buffer_store_dwordx4 v[108:111], v125, s[84:87], s7 offen nt
    s_add_u32 s7, s7, 32768
    s_waitcnt lgkmcnt(1)
    buffer_store_dwordx4 v[112:115], v125, s[84:87], s7 offen nt
    s_add_u32 s7, s7, 32768
    s_waitcnt lgkmcnt(0)
    buffer_store_dwordx4 v[116:119], v125, s[84:87], s7 offen nt
    s_endpgm
L_end:
    s_endpgm
.section .rodata,"a"
.p2align 6
.amdhsa_kernel concat_heads__grouped_kv_mqa__grouped_kv_mqa__prompt_kernel
  .amdhsa_next_free_vgpr 168
  .amdhsa_next_free_sgpr 102
  .amdhsa_accum_offset 168
  .amdhsa_group_segment_fixed_size 0
  .amdhsa_kernarg_size 104
  .amdhsa_user_sgpr_count 2
  .amdhsa_user_sgpr_kernarg_segment_ptr 1
  .amdhsa_system_sgpr_workgroup_id_x 1
.end_amdhsa_kernel
```
